```python
import torch

def _softmax(x, axis=-1):
    return torch.softmax(x, dim=axis)

def _gelu(x):
    return torch.nn.functional.gelu(x, approximate='tanh')

def _silu(x):
    return torch.nn.functional.silu(x)

def _sigmoid(x):
    return torch.sigmoid(x)

def _layernorm(x, axis=-1, eps=1e-05):
    m = x.mean(dim=axis, keepdim=True)
    v = x.var(dim=axis, keepdim=True, unbiased=False)
    return (x - m) / torch.sqrt(v + eps)

def _scatter_add(tgt, idx, src, axis=0):
    return tgt.clone().index_add_(axis, idx, src)

def _segment_sum(src, seg, n):
    out = torch.zeros((n,) + src.shape[1:], dtype=src.dtype)
    return out.index_add_(0, seg, src)

def _pad(x, pw):
    flat = tuple((v for pair in reversed(pw) for v in pair))
    return torch.nn.functional.pad(x, flat)
kernel_name = 'adaLN_cond__ssm_conv_s4__dense_activation_silu__prompt'

def setup_inputs():

    _w = lambda a: (lambda t: t.to(torch.bfloat16) if t.is_floating_point() else t)(torch.as_tensor(a))

    def _A_setup():
        B, L, D, N = (1, 2048, 512, 128)
        A_re = -(lambda _x: torch.exp(torch.as_tensor(_x)))((lambda *s: torch.randn(*s, dtype=torch.bfloat16) * 3.2)(D, N))
        A_im = torch.pi * (lambda *s: torch.randn(*s, dtype=torch.bfloat16) * 0.05)(D, N)
        B_re = (lambda *s: torch.randn(*s, dtype=torch.bfloat16) * 0.1)(D, N)
        B_im = (lambda *s: torch.randn(*s, dtype=torch.bfloat16) * 0.1)(D, N)
        C_re = (lambda *s: torch.randn(*s, dtype=torch.bfloat16) * 0.1)(D, N)
        C_im = (lambda *s: torch.randn(*s, dtype=torch.bfloat16) * 0.1)(D, N)
        log_dt = (lambda *s: torch.randn(*s, dtype=torch.bfloat16) * 0.05)(D) * 0.5 - 4.0
        Dskip = (lambda *s: torch.randn(*s, dtype=torch.bfloat16) * 0.05)(D)
        return {'u': _w((lambda *s: torch.randn(*s, dtype=torch.bfloat16) * 0.05)(B, L, D)), 'A_re': _w(A_re), 'A_im': _w(A_im), 'B_re': _w(B_re), 'B_im': _w(B_im), 'C_re': _w(C_re), 'C_im': _w(C_im), 'log_dt': _w(log_dt), 'Dskip': _w(Dskip)}
    _A_in = _A_setup()

    def _B_setup():
        B, S, D, F = (1, 2048, 512, 1792)
        return {'x': _w((lambda *s: torch.randn(*s, dtype=torch.bfloat16) * 0.05)(B, S, D)), 'w1': _w((lambda *s: torch.randn(*s, dtype=torch.bfloat16) * 3.2)(D, F) * D ** (-0.5)), 'w2': _w((lambda *s: torch.randn(*s, dtype=torch.bfloat16) * 0.4)(F, D) * F ** (-0.5))}
    _B_in = _B_setup()
    return {'A_u': _A_in['u'], 'A_A_re': _A_in['A_re'], 'A_A_im': _A_in['A_im'], 'A_B_re': _A_in['B_re'], 'A_B_im': _A_in['B_im'], 'A_C_re': _A_in['C_re'], 'A_C_im': _A_in['C_im'], 'A_log_dt': _A_in['log_dt'], 'A_Dskip': _A_in['Dskip'], 'B_x': _B_in['x'], 'B_w1': _B_in['w1'], 'B_w2': _B_in['w2'], 'c': _w((lambda *s: torch.randn(*s, dtype=torch.bfloat16) * 0.2)(1, 512) * 8.0), 'w_mod': _w((lambda *s: torch.randn(*s, dtype=torch.bfloat16) * 0.2)(512, 6 * 512) * 512 ** (-0.5) * 8.0)}

def reference(A_u, A_A_re, A_A_im, A_B_re, A_B_im, A_C_re, A_C_im, A_log_dt, A_Dskip, B_x, B_w1, B_w2, c, w_mod):

    def _A_ref(u, A_re, A_im, B_re, B_im, C_re, C_im, log_dt, Dskip):
        Bsz, L, D = u.shape
        dt = torch.exp(log_dt)[:, None]
        A = A_re + 1j * A_im
        Bc = B_re + 1j * B_im
        Cc = C_re + 1j * C_im
        logdA = dt * A
        dB = dt * Bc
        l = (lambda x, dt: x.to(dt))(torch.arange(L), A_re.dtype)
        P = torch.exp(logdA[:, :, None] * l[None, None, :])
        K = torch.einsum('dn,dnl,dn->dl', Cc, P, dB).real
        L2 = 2 * L
        Kp = _pad(K, ((0, 0), (0, L)))
        up = (lambda x, *d: x.permute(*d))(u, 0, 2, 1)
        up = _pad(up, ((0, 0), (0, 0), (0, L)))
        Kf = (lambda x, axes=(-2, -1): torch.fft.rfft2(x.float(), dim=axes))(Kp[:, None, :], axes=(-2, -1))
        Uf = (lambda x, axes=(-2, -1): torch.fft.rfft2(x.float(), dim=axes))(up[:, :, None, :], axes=(-2, -1))
        Yf = Uf * Kf[None, :, :, :]
        y = (lambda x, s, axes=(-2, -1): torch.fft.irfft2(x, s=s, dim=axes).to(torch.bfloat16))(Yf, (1, L2), axes=(-2, -1))[:, :, 0, :L]
        y = (lambda x, *d: x.permute(*d))(y, 0, 2, 1) + u * Dskip[None, None, :]
        return y

    def _B_ref(x, w1, w2):
        h = torch.einsum('bsd,df->bsf', x, w1)
        h = _silu(h)
        out = torch.einsum('bsf,fd->bsd', h, w2)
        return out
    x = A_u
    mod = (_silu(c) @ w_mod).reshape(c.shape[0], 6, 1, -1)
    sa, ca, ga, sb, cb, gb = (mod[:, 0].clone(), mod[:, 1].clone(), mod[:, 2].clone(), mod[:, 3].clone(), mod[:, 4].clone(), mod[:, 5].clone())
    h = _layernorm(x, axis=-1) * (1 + ca) + sa
    x = x + ga * _A_ref(h, A_A_re, A_A_im, A_B_re, A_B_im, A_C_re, A_C_im, A_log_dt, A_Dskip)
    h = _layernorm(x, axis=-1) * (1 + cb) + sb
    x = x + gb * _B_ref(h, B_w1, B_w2)
    return x
```

```asm
; @launch grid=(256,1,1) block=(256,1,1) lds=161792
.amdgcn_target "amdgcn-amd-amdhsa--gfx950"
.text
.globl adaLN_cond__ssm_conv_s4__dense_activation_silu__prompt_kernel
.p2align 8
.type adaLN_cond__ssm_conv_s4__dense_activation_silu__prompt_kernel,@function
adaLN_cond__ssm_conv_s4__dense_activation_silu__prompt_kernel:
    s_load_dwordx16 s[16:31], s[0:1], 0
    s_load_dwordx16 s[32:47], s[0:1], 64
    s_load_dwordx2 s[48:49], s[0:1], 128
    s_getpc_b64 s[82:83]
L_pf:
    s_lshr_b32 s4, s2, 3
    s_and_b32 s4, s4, 7
    s_mul_i32 s4, s4, 4096
    v_subrev_u32 v255, 192, v0
    v_cmp_gt_u32 vcc, 32, v255
    v_lshl_add_u32 v255, v255, 7, s4
    v_min_u32 v255, L_text_end-L_pf-4, v255
    s_and_saveexec_b64 s[80:81], vcc
    s_cbranch_execz L_pf2
    global_load_dword v255, v255, s[82:83]
L_pf2:
    s_mov_b64 exec, -1
    s_cmp_ge_u32 s2, 256
    s_cbranch_scc1 L_end
    s_memrealtime s[78:79]
    v_lshrrev_b32_e64 v1, 6, v0
    s_nop 0
    v_readfirstlane_b32 s50, v1
    v_and_b32 v1, 63, v0
    s_and_b32 s3, s2, 7
    s_lshr_b32 s4, s2, 3
    s_lshl_b32 s51, s3, 5
    s_add_u32 s80, s51, s4
    s_lshl_b32 s51, s80, 9
    v_lshl_add_u32 v2, v0, 1, s51
    v_mov_b32 v4, 0
    v_mov_b32 v5, 0
    v_mov_b32 v6, 0
    v_mov_b32 v7, 0
    v_mov_b32 v8, 0
    v_mov_b32 v9, 0
    v_mov_b32 v10, 0
    s_lshr_b32 s52, s50, 1
    s_lshl_b32 s53, s80, 1
    s_add_u32 s53, s53, s52
    s_lshl_b32 s54, s53, 1
    v_mov_b32 v3, s54
    v_lshrrev_b32 v77, 5, v0
    v_and_b32 v78, 31, v0
    v_lshlrev_b32_e64 v78, 4, v78
    v_lshl_add_u32 v79, v77, 10, v78
    s_lshl_b32 s63, s2, 13
    v_add_u32 v79, s63, v79
    s_waitcnt lgkmcnt(0)
    s_mov_b32 s34, s80
    s_or_b32 s78, s78, 1
    s_or_b32 s79, s2, s50
    s_cmp_eq_u32 s79, 0
    s_cbranch_scc0 L_nn
    v_mov_b32 v250, s78
    v_lshlrev_b32 v251, 6, v1
    s_mov_b64 exec, 15
    global_store_dword v251, v250, s[46:47] sc1
    s_mov_b64 exec, -1
L_nn:
    global_load_short_d16_hi v10, v3, s[30:31]
    global_load_short_d16_hi v4, v2, s[18:19]
    global_load_short_d16_hi v5, v2, s[20:21]
    global_load_short_d16_hi v6, v2, s[22:23]
    global_load_short_d16_hi v7, v2, s[24:25]
    global_load_short_d16_hi v8, v2, s[26:27]
    global_load_short_d16_hi v9, v2, s[28:29]
    global_load_dwordx4 v[240:243], v79, s[16:17]
    global_load_dwordx4 v[244:247], v79, s[16:17] offset:512
    s_and_b32 s5, s4, 3
    s_lshl_b32 s5, s5, 3
    s_add_u32 s5, s5, s3
    s_lshl_b32 s5, s5, 1
    s_bfe_u32 s6, s4, 0x10002
    s_add_u32 s5, s5, s6
    s_lshr_b32 s6, s4, 3
    s_cmp_ge_u32 s5, 48
    s_cselect_b32 s7, 16, 0
    s_add_u32 s7, s7, s5
    s_lshl_b32 s7, s7, 6
    s_lshl_b32 s8, s6, 2
    s_add_u32 s8, s8, s50
    s_mul_i32 s9, s8, 196608
    s_add_u32 s7, s7, s9
    v_lshrrev_b32 v250, 2, v1
    v_mul_u32_u24 v254, 6144, v250
    v_and_b32 v251, 3, v1
    v_lshl_add_u32 v254, v251, 4, v254
    s_lshl_b32 s9, s50, 12
    s_add_u32 s9, s9, 98304
    v_mov_b32 v231, v254
    s_lshl_b32 s8, s8, 6
    s_and_b32 s64, s4, 1
    s_lshl_b32 s64, s64, 3
    s_add_u32 s64, s64, s3
    s_lshl_b32 s64, s64, 1
    s_bfe_u32 s65, s4, 0x10001
    s_add_u32 s64, s64, s65
    s_lshr_b32 s65, s4, 2
    s_cmp_ge_u32 s64, 16
    s_cselect_b32 s66, 64, 48
    s_add_u32 s66, s66, s64
    s_lshl_b32 s66, s66, 6
    s_lshl_b32 s67, s65, 2
    s_add_u32 s67, s67, s50
    s_mul_i32 s68, s67, 98304
    s_add_u32 s66, s66, s68
    s_lshl_b32 s67, s67, 5
    s_sub_u32 s67, s67, 64
    v_min_u32 v248, 23, v1
    v_cmp_gt_u32 vcc, 16, v248
    v_mov_b32 v250, s67
    v_mov_b32_e64 v251, s8
    v_cndmask_b32 v250, v250, v251, vcc
    v_lshl_add_u32 v248, v248, 2, v250
    global_load_dword v248, v248, s[40:41]
    s_lshl_b32 s60, s34, 2
    s_load_dword s30, s[32:33], s60
    s_cmp_lt_u32 s2, 112
    s_cbranch_scc0 L_pj_w1
    s_lshl_b32 s76, s2, 14
    s_lshl_b32 s70, s50, 12
    s_add_u32 s76, s76, s70
    s_add_u32 s72, s38, s76
    s_addc_u32 s73, s39, 0
    s_add_u32 s31, s70, 145408
    s_movk_i32 s79, 1024
    v_xor_b32 v224, 0, v1
    v_lshlrev_b32 v224, 4, v224
    v_xor_b32 v225, 4, v1
    v_lshlrev_b32_e64 v225, 4, v225
    v_add_u32 v225, 1024, v225
    v_xor_b32 v226, 8, v1
    v_lshlrev_b32 v226, 4, v226
    v_add_u32 v226, 2048, v226
    v_xor_b32_e64 v227, 12, v1
    v_lshlrev_b32 v227, 4, v227
    v_add_u32 v227, 3072, v227
    s_branch L_pj_go
L_pj_w1:
    s_sub_u32 s75, s2, 112
    s_min_u32 s75, s75, 111
    s_and_b32 s26, s75, 7
    s_lshr_b32 s27, s75, 3
    s_lshl_b32 s75, s26, 4
    s_add_u32 s75, s75, s50
    s_mul_i32 s75, s75, 14336
    s_lshl_b32 s76, s27, 8
    s_add_u32 s75, s75, s76
    s_add_u32 s72, s36, s75
    s_addc_u32 s73, s37, 0
    s_lshl_b32 s31, s50, 10
    s_add_u32 s31, s31, 145408
    s_movk_i32 s79, 4096
    v_lshrrev_b32 v228, 4, v1
    v_and_b32 v229, 15, v1
    v_lshlrev_b32 v230, 2, v228
    v_xor_b32 v230, v230, v229
    v_mul_u32_u24 v224, 3584, v228
    v_lshl_add_u32 v224, v230, 4, v224
    v_add_u32 v225, 57344, v224
    v_add_u32 v226, 114688, v224
    v_add_u32 v227, 172032, v224
L_pj_go:
    s_and_b32 s75, s5, 15
    s_lshl_b32 s75, s75, 13
    s_lshr_b32 s76, s5, 4
    s_lshl_b32 s76, s76, 6
    s_add_u32 s75, s75, s76
    s_lshl_b32 s76, s6, 3
    s_add_u32 s75, s75, s76
    s_and_b32 s76, s64, 15
    s_lshl_b32 s76, s76, 13
    s_lshr_b32 s77, s64, 4
    s_lshl_b32 s77, s77, 7
    s_add_u32 s76, s76, s77
    s_lshl_b32 s77, s65, 3
    s_add_u32 s76, s76, s77
    s_add_u32 s76, s76, 256
    s_cmp_eq_u32 s50, 0
    s_cselect_b32 s75, s75, s76
    s_add_u32 s16, s75, 0x820000
    s_add_u32 s16, s48, s16
    s_addc_u32 s17, s49, 0
    v_mov_b32 v12, 0
    v_mov_b32 v13, 0
    v_mov_b32 v14, 0
    v_mov_b32 v15, 0
    s_add_u32 s14, s48, 0xf00000
    s_addc_u32 s15, s49, 0
    v_lshrrev_b32 v250, 5, v1
    v_mul_u32_u24_e64 v250, 8, v250
    v_bfe_u32 v251, v1, 2, 2
    v_add_u32 v250, v250, v251
    v_lshlrev_b32 v254, 6, v250
    v_bfe_u32 v250, v1, 4, 1
    v_lshl_add_u32 v254, v250, 5, v254
    v_and_b32_e64 v250, 3, v1
    v_lshl_add_u32 v254, v250, 3, v254
    v_add_u32 v254, s9, v254
    v_and_b32 v40, 31, v1
    v_lshrrev_b32 v41, 5, v1
    v_lshrrev_b32 v253, 1, v40
    v_lshlrev_b32 v253, 9, v253
    v_and_b32 v250, 1, v40
    s_add_u32 s75, s50, 5
    v_lshlrev_b32 v250, s75, v250
    v_add_u32_e64 v253, v253, v250
    v_mul_u32_u24 v11, 1056, v77
    v_add_u32_e64 v11, v11, v78
    v_add_u32 v11, 118784, v11
    v_bfe_u32 v56, v1, 2, 3
    v_mul_u32_u24 v236, 1056, v56
    v_and_b32_e64 v57, 3, v1
    v_lshl_add_u32 v236, v57, 3, v236
    v_lshl_add_u32 v236, v41, 5, v236
    s_lshl_b32 s75, s50, 8
    s_add_u32 s75, s75, 118784
    v_add_u32 v236, s75, v236
    v_and_b32_e64 v57, 15, v1
    v_lshl_add_u32 v57, v41, 4, v57
    v_lshlrev_b32 v235, 5, v57
    v_bfe_u32 v57, v1, 4, 1
    v_lshl_add_u32 v235, v57, 4, v235
    s_lshl_b32 s75, s2, 10
    s_lshl_b32 s76, s50, 20
    s_add_u32 s75, s75, s76
    s_add_u32 s12, s75, 0x0
    s_add_u32 s12, s48, s12
    s_addc_u32 s13, s49, 0
    s_lshl_b32 s75, s2, 6
    s_lshl_b32 s76, s50, 4
    s_add_u32 s75, s75, s76
    s_add_u32 s24, s75, 0x800000
    s_add_u32 s24, s48, s24
    s_addc_u32 s25, s49, 0
    s_mov_b32 s58, 0xffff0000
    s_mov_b32 s63, 0x3f803f80
    v_lshlrev_b32_e64 v249, 2, v0
    v_add_u32 v249, 114688, v249
    v_lshlrev_b32 v233, 4, v41
    s_lshl_b32 s75, s50, 8
    s_add_u32 s75, s75, 114688
    v_add_u32 v233, s75, v233
    s_lshl_b32 s75, s50, 10
    v_lshl_add_u32 v252, v1, 2, s75
    v_add_u32 v252, 115712, v252
    s_lshl_b32 s55, s50, 14
    v_lshl_add_u32 v16, v1, 2, s55
    v_xor_b32 v17, 16, v16
    v_xor_b32 v18, 32, v16
    v_xor_b32 v19, 48, v16
    v_xor_b32_e64 v20, 64, v16
    v_xor_b32 v21, 80, v16
    v_xor_b32 v22, 96, v16
    v_xor_b32 v23, 112, v16
    v_xor_b32 v24, 128, v16
    v_xor_b32 v25, 144, v16
    v_xor_b32 v26, 160, v16
    v_xor_b32 v27, 176, v16
    v_xor_b32 v28, 192, v16
    v_xor_b32 v29, 208, v16
    v_xor_b32 v30, 224, v16
    v_xor_b32 v31, 240, v16
    v_and_b32 v42, 15, v1
    v_xor_b32 v42, v42, v41
    v_lshlrev_b32_e64 v42, 4, v42
    v_lshl_add_u32 v42, v40, 8, v42
    v_add_u32 v32, s55, v42
    v_xor_b32 v33, 32, v32
    v_xor_b32_e64 v34, 64, v32
    v_xor_b32 v35, 96, v32
    v_xor_b32 v36, 128, v32
    v_xor_b32 v37, 160, v32
    v_xor_b32 v38, 192, v32
    v_xor_b32 v39, 224, v32
    s_mul_i32 s56, s52, 7168
    s_add_u32 s56, s56, 4294966304
    v_lshlrev_b32 v42, 3, v40
    v_cvt_f32_u32 v42, v42
    v_cvt_f32_u32_e64 v43, v41
    v_fmamk_f32 v56, v43, 0x40800000, v42
    v_max_f32_e64 v56, 0.5, v56
    v_cvt_pk_bf16_f32 v56, v56, 0
    v_lshrrev_b32 v77, 5, v56
    v_add_u32 v56, v56, v77
    v_lshl_add_u32 v44, v56, 2, s56
    v_fmamk_f32 v56, v43, 0x40800000, v42
    v_add_f32_e64 v56, 0x3f800000, v56
    v_cvt_pk_bf16_f32 v56, v56, 0
    v_lshrrev_b32 v77, 5, v56
    v_add_u32 v56, v56, v77
    v_lshl_add_u32 v45, v56, 2, s56
    v_fmamk_f32 v56, v43, 0x40800000, v42
    v_add_f32_e64 v56, 0x40000000, v56
    v_cvt_pk_bf16_f32 v56, v56, 0
    v_lshrrev_b32 v77, 5, v56
    v_add_u32 v56, v56, v77
    v_lshl_add_u32 v46, v56, 2, s56
    v_fmamk_f32 v56, v43, 0x40800000, v42
    v_add_f32 v56, 0x40400000, v56
    v_cvt_pk_bf16_f32 v56, v56, 0
    v_lshrrev_b32 v77, 5, v56
    v_add_u32 v56, v56, v77
    v_lshl_add_u32 v47, v56, 2, s56
    v_fmamk_f32 v56, v43, 0x43800000, v42
    v_add_f32 v56, 0x43800000, v56
    v_cvt_pk_bf16_f32 v56, v56, 0
    v_lshrrev_b32 v77, 5, v56
    v_add_u32 v56, v56, v77
    v_lshl_add_u32 v48, v56, 2, s56
    v_fmamk_f32 v56, v43, 0x43810000, v42
    v_add_f32 v56, 0x43810000, v56
    v_cvt_pk_bf16_f32 v56, v56, 0
    v_lshrrev_b32 v77, 5, v56
    v_add_u32 v56, v56, v77
    v_lshl_add_u32 v49, v56, 2, s56
    v_fmamk_f32 v56, v43, 0x43fe0000, v42
    v_add_f32 v56, 0x43820000, v56
    v_cvt_pk_bf16_f32 v56, v56, 0
    v_lshrrev_b32 v77, 5, v56
    v_add_u32 v56, v56, v77
    v_lshl_add_u32 v50, v56, 2, s56
    v_fmamk_f32 v56, v43, 0x43ff0000, v42
    v_add_f32 v56, 0x43830000, v56
    v_cvt_pk_bf16_f32 v56, v56, 0
    v_lshrrev_b32_e64 v77, 5, v56
    v_add_u32 v56, v56, v77
    v_lshl_add_u32 v51, v56, 2, s56
    v_cmp_eq_u32 vcc, 32, v1
    v_fmaak_f32 v57, 4.0, v42, 0x45800000
    v_mov_b32 v58, 0x45000000
    v_cndmask_b32 v58, v57, v58, vcc
    v_cmp_lt_u32 vcc, 31, v1
    v_add_f32 v56, 0x44800000, v42
    s_nop 0
    v_cndmask_b32 v56, v56, v58, vcc
    v_cvt_pk_bf16_f32 v56, v56, 0
    v_lshrrev_b32 v77, 5, v56
    v_add_u32 v56, v56, v77
    v_lshl_add_u32 v52, v56, 2, s56
    v_add_f32 v56, 0x44a00000, v42
    v_cndmask_b32_e64 v56, v56, v57, vcc
    v_cvt_pk_bf16_f32 v56, v56, 0
    v_lshrrev_b32 v77, 5, v56
    v_add_u32 v56, v56, v77
    v_lshl_add_u32 v53, v56, 2, s56
    v_add_f32 v56, 0x44c00000, v42
    v_cndmask_b32_e64 v56, v56, v57, vcc
    v_cvt_pk_bf16_f32 v56, v56, 0
    v_lshrrev_b32 v77, 5, v56
    v_add_u32 v56, v56, v77
    v_lshl_add_u32 v54, v56, 2, s56
    v_add_f32 v56, 0x44e00000, v42
    v_cndmask_b32_e64 v56, v56, v57, vcc
    v_cvt_pk_bf16_f32 v56, v56, 0
    v_lshrrev_b32 v77, 5, v56
    v_add_u32 v56, v56, v77
    v_lshl_add_u32 v55, v56, 2, s56
    v_and_b32 v59, 127, v0
    s_mov_b32 s57, 0x07060302
    s_mov_b32 s59, 0x3fb8aa3b
    s_mov_b32 s60, 0x3e22f983
    s_mov_b32 s61, 0x31dc9c88
    s_mov_b32 s62, 0x32a57060
    s_lshl_b32 s75, s50, 6
    v_mov_b32_e64 v234, s75
    global_load_dword v232, v234, s[46:47] sc1
    s_add_u32 s10, s42, s7
    s_addc_u32 s11, s43, 0
    s_mov_b32 m0, s9
    s_nop 0
    global_load_lds_dwordx4 v231, s[10:11]
    s_add_u32 s10, s10, 97280
    s_addc_u32 s11, s11, 0
    global_load_lds_dwordx4 v231, s[10:11] offset:1024
    s_add_u32 s10, s42, s66
    s_addc_u32 s11, s43, 0
    s_add_u32 m0, s9, 2048
    s_nop 0
    global_load_lds_dwordx4 v231, s[10:11]
    s_mov_b32 m0, s31
    s_nop 0
    global_load_lds_dwordx4 v224, s[72:73]
    s_add_u32 s31, s31, s79
    s_mov_b32 m0, s31
    s_nop 0
    global_load_lds_dwordx4 v225, s[72:73]
    s_add_u32 s31, s31, s79
    s_mov_b32 m0, s31
    s_nop 0
    global_load_lds_dwordx4 v226, s[72:73]
    s_add_u32 s31, s31, s79
    s_mov_b32 m0, s31
    s_nop 0
    global_load_lds_dwordx4 v227, s[72:73]
    s_add_u32 s31, s31, s79
    s_cmp_lt_u32 s2, 112
    s_cbranch_scc0 L_pa_w1
    v_lshrrev_b32 v250, 5, v1
    v_mul_u32_u24_e64 v250, 4, v250
    v_bfe_u32 v251, v1, 2, 2
    v_add_u32 v250, v250, v251
    v_lshlrev_b32 v224, 10, v250
    v_bfe_u32 v250, v1, 4, 1
    v_lshl_add_u32 v224, v250, 5, v224
    v_and_b32 v250, 3, v1
    v_lshl_add_u32 v224, v250, 3, v224
    s_lshl_b32 s76, s50, 8
    s_add_u32 s76, s76, 145408
    v_add_u32_e64 v224, s76, v224
    v_bfe_u32 v251, v1, 2, 2
    v_lshlrev_b32 v251, 6, v251
    v_xor_b32 v224, v224, v251
    v_xor_b32_e64 v225, 64, v224
    v_xor_b32 v226, 128, v224
    v_xor_b32 v227, 192, v224
    s_mul_i32 s76, s50, 458752
    s_lshl_b32 s75, s2, 10
    s_add_u32 s76, s76, s75
    s_add_u32 s70, s76, 0x900000
    s_add_u32 s70, s48, s70
    s_addc_u32 s71, s49, 0
    s_mov_b32 s75, 114688
    s_movk_i32 s76, 8192
    s_branch L_pa_go
L_pa_w1:
    v_lshrrev_b32 v250, 5, v1
    v_mul_u32_u24 v250, 8, v250
    v_bfe_u32 v251, v1, 2, 2
    v_add_u32 v250, v250, v251
    v_lshlrev_b32 v224, 8, v250
    v_bfe_u32 v250, v1, 4, 1
    v_lshl_add_u32 v224, v250, 5, v224
    v_and_b32_e64 v250, 3, v1
    v_lshl_add_u32 v224, v250, 3, v224
    v_bfe_u32 v251, v1, 2, 2
    v_xor_b32_e64 v251, s50, v251
    v_lshl_add_u32 v224, v251, 6, v224
    v_add_u32 v224, 145408, v224
    v_add_u32 v225, 4096, v224
    v_add_u32 v226, 8192, v224
    v_add_u32 v227, 12288, v224
    s_lshl_b32 s76, s27, 2
    s_add_u32 s76, s76, s50
    s_lshl_b32 s76, s76, 15
    s_lshl_b32 s75, s26, 12
    s_add_u32 s76, s76, s75
    s_add_u32 s70, s76, 0x1800000
    s_add_u32 s70, s48, s70
    s_addc_u32 s71, s49, 0
    s_movk_i32 s75, 1024
    s_movk_i32 s76, 1024
L_pa_go:
    v_add_u32 v228, s76, v224
    v_add_u32 v229, s76, v225
    v_add_u32 v230, s76, v226
    v_add_u32 v231, s76, v227
    v_lshlrev_b32 v223, 4, v1
    v_add_u32 v237, s75, v223
    v_add_u32 v238, s75, v237
    v_add_u32 v239, s75, v238
    s_lshr_b32 s5, s3, 1
    s_lshl_b32 s5, s5, 2
    s_and_b32 s75, s4, 3
    s_add_u32 s5, s5, s75
    s_and_b32 s7, s3, 1
    s_mul_i32 s7, s7, 7
    s_lshr_b32 s75, s4, 2
    s_add_u32 s7, s7, s75
    s_min_u32 s7, s7, 13
    s_lshl_b32 s6, s7, 2
    s_add_u32 s6, s6, s50
    s_waitcnt lgkmcnt(0)
    s_waitcnt vmcnt(11)
    v_mov_b32 v255, v223
    v_mul_f32 v78, s59, v10
    v_fma_f32 v79, v10, s59, -v78
    v_fma_f32 v79, v10, s62, v79
    v_exp_f32_e64 v78, v78
    v_mul_f32 v79, 0x3f317218, v79
    v_fma_f32 v78, v78, v79, v78
    v_cvt_pk_bf16_f32 v78, v78, v78
    v_and_b32 v78, s58, v78
    v_mul_f32 v4, v78, v4
    v_mul_f32 v5, v78, v5
    v_mul_f32 v152, v78, v6
    v_mul_f32_e64 v154, v78, v7
    v_pk_mul_f32 v[96:97], v[8:9], v[152:153] op_sel:[0,0] op_sel_hi:[1,0]
    v_pk_fma_f32 v[96:97], v[8:9], v[154:155], v[96:97] op_sel:[1,0,0] op_sel_hi:[0,0,1] neg_lo:[1,0,0]
    v_mul_f32 v4, s59, v4
    v_mul_f32 v88, 0x3f800000, v4
    v_mul_f32 v92, 0x43800000, v4
    v_mul_f32_e64 v89, 0x3f800000, v5
    v_mul_f32 v93, 0x43800000, v5
    v_exp_f32 v88, v88
    v_exp_f32 v92, v92
    v_mul_f32 v90, s60, v89
    v_mul_f32 v94, s60, v93
    v_fma_f32 v91, v89, s60, -v90
    v_fma_f32 v95, v93, s60, -v94
    v_fma_f32 v91, v89, s61, v91
    v_fma_f32 v95, v93, s61, v95
    v_fract_f32 v90, v90
    v_fract_f32 v94, v94
    v_add_f32 v90, v90, v91
    v_add_f32 v94, v94, v95
    v_cos_f32 v91, v90
    v_cos_f32 v95, v94
    v_sin_f32 v90, v90
    v_sin_f32 v94, v94
    v_mul_f32 v80, v88, v91
    v_mul_f32 v84, v92, v95
    v_mul_f32 v82, v88, v90
    v_mul_f32 v86, v92, v94
    v_mul_f32 v88, 0x41000000, v4
    v_mul_f32 v92, 0x43000000, v4
    v_mul_f32 v89, 0x41000000, v5
    v_mul_f32 v93, 0x43000000, v5
    v_exp_f32 v88, v88
    v_exp_f32 v92, v92
    v_mul_f32 v90, s60, v89
    v_mul_f32 v94, s60, v93
    v_fma_f32 v91, v89, s60, -v90
    v_fma_f32 v95, v93, s60, -v94
    v_fma_f32 v91, v89, s61, v91
    v_fma_f32 v95, v93, s61, v95
    v_fract_f32 v90, v90
    v_fract_f32 v94, v94
    v_add_f32 v90, v90, v91
    v_add_f32 v94, v94, v95
    v_cos_f32 v91, v90
    v_cos_f32 v95, v94
    v_sin_f32 v90, v90
    v_sin_f32 v94, v94
    v_mul_f32 v152, v88, v91
    v_mul_f32 v156, v92, v95
    v_mul_f32 v154, v88, -v90
    v_mul_f32 v158, v92, -v94
    v_pk_mul_f32 v[98:99], v[96:97], v[80:81] op_sel:[0,0] op_sel_hi:[1,0]
    v_perm_b32 v144, v97, v96, s57
    v_and_b32 v140, s58, v96
    v_and_b32 v141, s58, v97
    v_pk_fma_f32 v[98:99], v[96:97], v[82:83], v[98:99] op_sel:[1,0,0] op_sel_hi:[0,0,1] neg_lo:[1,0,0]
    v_pk_add_f32 v[142:143], v[96:97], v[140:141] neg_lo:[0,1] neg_hi:[0,1]
    v_cvt_pk_bf16_f32 v145, v142, v143
    ds_write2st64_b32 v16, v144, v145 offset0:0 offset1:32
    v_pk_mul_f32 v[112:113], v[96:97], v[84:85] op_sel:[0,0] op_sel_hi:[1,0]
    v_perm_b32 v150, v99, v98, s57
    v_and_b32 v146, s58, v98
    v_and_b32 v147, s58, v99
    v_pk_fma_f32 v[112:113], v[96:97], v[86:87], v[112:113] op_sel:[1,0,0] op_sel_hi:[0,0,1] neg_lo:[1,0,0]
    v_pk_add_f32 v[148:149], v[98:99], v[146:147] neg_lo:[0,1] neg_hi:[0,1]
    v_cvt_pk_bf16_f32 v151, v148, v149
    ds_write2st64_b32 v17, v150, v151 offset0:1 offset1:33
    v_pk_mul_f32 v[100:101], v[98:99], v[80:81] op_sel:[0,0] op_sel_hi:[1,0]
    v_perm_b32 v144, v113, v112, s57
    v_and_b32 v140, s58, v112
    v_and_b32 v141, s58, v113
    v_pk_fma_f32 v[100:101], v[98:99], v[82:83], v[100:101] op_sel:[1,0,0] op_sel_hi:[0,0,1] neg_lo:[1,0,0]
    v_pk_add_f32 v[142:143], v[112:113], v[140:141] neg_lo:[0,1] neg_hi:[0,1]
    v_cvt_pk_bf16_f32 v145, v142, v143
    ds_write2st64_b32 v24, v144, v145 offset0:8 offset1:40
    v_pk_mul_f32 v[120:121], v[112:113], v[84:85] op_sel:[0,0] op_sel_hi:[1,0]
    v_perm_b32 v150, v101, v100, s57
    v_and_b32 v146, s58, v100
    v_and_b32 v147, s58, v101
    v_pk_fma_f32 v[120:121], v[112:113], v[86:87], v[120:121] op_sel:[1,0,0] op_sel_hi:[0,0,1] neg_lo:[1,0,0]
    v_pk_add_f32 v[148:149], v[100:101], v[146:147] neg_lo:[0,1] neg_hi:[0,1]
    v_cvt_pk_bf16_f32 v151, v148, v149
    ds_write2st64_b32 v18, v150, v151 offset0:2 offset1:34
    v_pk_mul_f32 v[102:103], v[100:101], v[80:81] op_sel:[0,0] op_sel_hi:[1,0]
    v_perm_b32 v144, v121, v120, s57
    v_and_b32 v140, s58, v120
    v_and_b32 v141, s58, v121
    v_pk_fma_f32 v[102:103], v[100:101], v[82:83], v[102:103] op_sel:[1,0,0] op_sel_hi:[0,0,1] neg_lo:[1,0,0]
    v_pk_add_f32 v[142:143], v[120:121], v[140:141] neg_lo:[0,1] neg_hi:[0,1]
    v_cvt_pk_bf16_f32 v145, v142, v143
    ds_write2st64_b32 v28, v144, v145 offset0:12 offset1:44
    v_pk_mul_f32 v[124:125], v[120:121], v[84:85] op_sel:[0,0] op_sel_hi:[1,0]
    v_perm_b32 v150, v103, v102, s57
    v_and_b32 v146, s58, v102
    v_and_b32 v147, s58, v103
    v_pk_fma_f32 v[124:125], v[120:121], v[86:87], v[124:125] op_sel:[1,0,0] op_sel_hi:[0,0,1] neg_lo:[1,0,0]
    v_pk_add_f32 v[148:149], v[102:103], v[146:147] neg_lo:[0,1] neg_hi:[0,1]
    v_cvt_pk_bf16_f32 v151, v148, v149
    ds_write2st64_b32 v19, v150, v151 offset0:3 offset1:35
    v_pk_mul_f32 v[104:105], v[102:103], v[80:81] op_sel:[0,0] op_sel_hi:[1,0]
    v_perm_b32 v144, v125, v124, s57
    v_and_b32 v140, s58, v124
    v_and_b32 v141, s58, v125
    v_pk_fma_f32 v[104:105], v[102:103], v[82:83], v[104:105] op_sel:[1,0,0] op_sel_hi:[0,0,1] neg_lo:[1,0,0]
    v_pk_add_f32 v[142:143], v[124:125], v[140:141] neg_lo:[0,1] neg_hi:[0,1]
    v_cvt_pk_bf16_f32 v145, v142, v143
    ds_write2st64_b32 v30, v144, v145 offset0:14 offset1:46
    v_pk_mul_f32 v[128:129], v[124:125], v[84:85] op_sel:[0,0] op_sel_hi:[1,0]
    v_perm_b32 v150, v105, v104, s57
    v_and_b32 v146, s58, v104
    v_and_b32 v147, s58, v105
    v_pk_fma_f32 v[128:129], v[124:125], v[86:87], v[128:129] op_sel:[1,0,0] op_sel_hi:[0,0,1] neg_lo:[1,0,0]
    v_pk_add_f32 v[148:149], v[104:105], v[146:147] neg_lo:[0,1] neg_hi:[0,1]
    v_cvt_pk_bf16_f32 v151, v148, v149
    ds_write2st64_b32 v20, v150, v151 offset0:4 offset1:36
    v_pk_mul_f32 v[106:107], v[104:105], v[80:81] op_sel:[0,0] op_sel_hi:[1,0]
    v_perm_b32 v144, v129, v128, s57
    v_and_b32 v140, s58, v128
    v_and_b32 v141, s58, v129
    v_pk_fma_f32 v[106:107], v[104:105], v[82:83], v[106:107] op_sel:[1,0,0] op_sel_hi:[0,0,1] neg_lo:[1,0,0]
    v_pk_add_f32 v[142:143], v[128:129], v[140:141] neg_lo:[0,1] neg_hi:[0,1]
    v_cvt_pk_bf16_f32 v145, v142, v143
    ds_write2st64_b32 v16, v144, v145 offset0:16 offset1:48
    v_pk_mul_f32 v[130:131], v[128:129], v[84:85] op_sel:[0,0] op_sel_hi:[1,0]
    v_perm_b32 v150, v107, v106, s57
    v_and_b32 v146, s58, v106
    v_and_b32 v147, s58, v107
    v_pk_fma_f32 v[130:131], v[128:129], v[86:87], v[130:131] op_sel:[1,0,0] op_sel_hi:[0,0,1] neg_lo:[1,0,0]
    v_pk_add_f32 v[148:149], v[106:107], v[146:147] neg_lo:[0,1] neg_hi:[0,1]
    v_cvt_pk_bf16_f32 v151, v148, v149
    ds_write2st64_b32 v21, v150, v151 offset0:5 offset1:37
    v_pk_mul_f32 v[108:109], v[106:107], v[80:81] op_sel:[0,0] op_sel_hi:[1,0]
    v_perm_b32 v144, v131, v130, s57
    v_and_b32 v140, s58, v130
    v_and_b32 v141, s58, v131
    v_pk_fma_f32 v[108:109], v[106:107], v[82:83], v[108:109] op_sel:[1,0,0] op_sel_hi:[0,0,1] neg_lo:[1,0,0]
    v_pk_add_f32 v[142:143], v[130:131], v[140:141] neg_lo:[0,1] neg_hi:[0,1]
    v_cvt_pk_bf16_f32 v145, v142, v143
    ds_write2st64_b32 v17, v144, v145 offset0:17 offset1:49
    v_pk_mul_f32 v[132:133], v[130:131], v[84:85] op_sel:[0,0] op_sel_hi:[1,0]
    v_perm_b32 v150, v109, v108, s57
    v_and_b32 v146, s58, v108
    v_and_b32 v147, s58, v109
    v_pk_fma_f32 v[132:133], v[130:131], v[86:87], v[132:133] op_sel:[1,0,0] op_sel_hi:[0,0,1] neg_lo:[1,0,0]
    v_pk_add_f32 v[148:149], v[108:109], v[146:147] neg_lo:[0,1] neg_hi:[0,1]
    v_cvt_pk_bf16_f32 v151, v148, v149
    ds_write2st64_b32 v22, v150, v151 offset0:6 offset1:38
    v_pk_mul_f32 v[110:111], v[108:109], v[80:81] op_sel:[0,0] op_sel_hi:[1,0]
    v_perm_b32 v144, v133, v132, s57
    v_and_b32 v140, s58, v132
    v_and_b32 v141, s58, v133
    v_pk_fma_f32 v[110:111], v[108:109], v[82:83], v[110:111] op_sel:[1,0,0] op_sel_hi:[0,0,1] neg_lo:[1,0,0]
    v_pk_add_f32 v[142:143], v[132:133], v[140:141] neg_lo:[0,1] neg_hi:[0,1]
    v_cvt_pk_bf16_f32 v145, v142, v143
    ds_write2st64_b32 v18, v144, v145 offset0:18 offset1:50
    v_pk_mul_f32 v[134:135], v[132:133], v[84:85] op_sel:[0,0] op_sel_hi:[1,0]
    v_perm_b32 v150, v111, v110, s57
    v_and_b32 v146, s58, v110
    v_and_b32 v147, s58, v111
    v_pk_fma_f32 v[134:135], v[132:133], v[86:87], v[134:135] op_sel:[1,0,0] op_sel_hi:[0,0,1] neg_lo:[1,0,0]
    v_pk_add_f32 v[148:149], v[110:111], v[146:147] neg_lo:[0,1] neg_hi:[0,1]
    v_cvt_pk_bf16_f32 v151, v148, v149
    ds_write2st64_b32 v23, v150, v151 offset0:7 offset1:39
    v_pk_mul_f32 v[114:115], v[100:101], v[84:85] op_sel:[0,0] op_sel_hi:[1,0]
    v_perm_b32 v144, v135, v134, s57
    v_and_b32 v140, s58, v134
    v_and_b32 v141, s58, v135
    v_pk_fma_f32 v[114:115], v[100:101], v[86:87], v[114:115] op_sel:[1,0,0] op_sel_hi:[0,0,1] neg_lo:[1,0,0]
    v_pk_add_f32 v[142:143], v[134:135], v[140:141] neg_lo:[0,1] neg_hi:[0,1]
    v_cvt_pk_bf16_f32 v145, v142, v143
    ds_write2st64_b32 v19, v144, v145 offset0:19 offset1:51
    v_pk_mul_f32 v[136:137], v[134:135], v[84:85] op_sel:[0,0] op_sel_hi:[1,0]
    v_perm_b32 v150, v115, v114, s57
    v_and_b32 v146, s58, v114
    v_and_b32 v147, s58, v115
    v_pk_fma_f32 v[136:137], v[134:135], v[86:87], v[136:137] op_sel:[1,0,0] op_sel_hi:[0,0,1] neg_lo:[1,0,0]
    v_pk_add_f32 v[148:149], v[114:115], v[146:147] neg_lo:[0,1] neg_hi:[0,1]
    v_cvt_pk_bf16_f32 v151, v148, v149
    ds_write2st64_b32 v25, v150, v151 offset0:9 offset1:41
    v_pk_mul_f32 v[116:117], v[104:105], v[84:85] op_sel:[0,0] op_sel_hi:[1,0]
    v_perm_b32 v144, v137, v136, s57
    v_and_b32 v140, s58, v136
    v_and_b32 v141, s58, v137
    v_pk_fma_f32 v[116:117], v[104:105], v[86:87], v[116:117] op_sel:[1,0,0] op_sel_hi:[0,0,1] neg_lo:[1,0,0]
    v_pk_add_f32 v[142:143], v[136:137], v[140:141] neg_lo:[0,1] neg_hi:[0,1]
    v_cvt_pk_bf16_f32 v145, v142, v143
    ds_write2st64_b32 v20, v144, v145 offset0:20 offset1:52
    v_pk_mul_f32 v[118:119], v[108:109], v[84:85] op_sel:[0,0] op_sel_hi:[1,0]
    v_perm_b32 v150, v117, v116, s57
    v_and_b32 v146, s58, v116
    v_and_b32 v147, s58, v117
    v_pk_fma_f32 v[118:119], v[108:109], v[86:87], v[118:119] op_sel:[1,0,0] op_sel_hi:[0,0,1] neg_lo:[1,0,0]
    v_pk_add_f32 v[148:149], v[116:117], v[146:147] neg_lo:[0,1] neg_hi:[0,1]
    v_cvt_pk_bf16_f32 v151, v148, v149
    ds_write2st64_b32 v26, v150, v151 offset0:10 offset1:42
    v_pk_mul_f32 v[122:123], v[116:117], v[84:85] op_sel:[0,0] op_sel_hi:[1,0]
    v_perm_b32 v144, v119, v118, s57
    v_and_b32 v140, s58, v118
    v_and_b32 v141, s58, v119
    v_pk_fma_f32 v[122:123], v[116:117], v[86:87], v[122:123] op_sel:[1,0,0] op_sel_hi:[0,0,1] neg_lo:[1,0,0]
    v_pk_add_f32 v[142:143], v[118:119], v[140:141] neg_lo:[0,1] neg_hi:[0,1]
    v_cvt_pk_bf16_f32 v145, v142, v143
    ds_write2st64_b32 v27, v144, v145 offset0:11 offset1:43
    v_pk_mul_f32 v[126:127], v[122:123], v[84:85] op_sel:[0,0] op_sel_hi:[1,0]
    v_perm_b32 v150, v123, v122, s57
    v_and_b32 v146, s58, v122
    v_and_b32 v147, s58, v123
    v_pk_fma_f32 v[126:127], v[122:123], v[86:87], v[126:127] op_sel:[1,0,0] op_sel_hi:[0,0,1] neg_lo:[1,0,0]
    v_pk_add_f32 v[148:149], v[122:123], v[146:147] neg_lo:[0,1] neg_hi:[0,1]
    v_cvt_pk_bf16_f32 v151, v148, v149
    ds_write2st64_b32 v29, v150, v151 offset0:13 offset1:45
    v_perm_b32 v144, v127, v126, s57
    v_and_b32 v140, s58, v126
    v_and_b32 v141, s58, v127
    v_pk_add_f32 v[142:143], v[126:127], v[140:141] neg_lo:[0,1] neg_hi:[0,1]
    v_cvt_pk_bf16_f32 v145, v142, v143
    ds_write2st64_b32 v31, v144, v145 offset0:15 offset1:47
    ds_read_b128 v[160:163], v32
    ds_read_b128 v[192:195], v32 offset:8192
    ds_read_b128 v[164:167], v33
    ds_read_b128 v[196:199], v33 offset:8192
    ds_read_b128 v[168:171], v34
    ds_read_b128 v[200:203], v34 offset:8192
    ds_read_b128 v[172:175], v35
    ds_read_b128 v[204:207], v35 offset:8192
    ds_read_b128 v[176:179], v36
    ds_read_b128 v[208:211], v36 offset:8192
    ds_read_b128 v[180:183], v37
    ds_read_b128 v[212:215], v37 offset:8192
    ds_read_b128 v[184:187], v38
    ds_read_b128 v[216:219], v38 offset:8192
    ds_read_b128 v[188:191], v39
    ds_read_b128 v[220:223], v39 offset:8192
    v_mov_b32 v96, 0
    v_mov_b32 v97, 0
    v_mov_b32_e64 v98, 0
    v_mov_b32 v99, 0
    s_waitcnt vmcnt(9)
    ds_write_b128 v11, v[240:243] offset:0
    ds_write_b128 v11, v[244:247] offset:512
    v_dot2c_f32_bf16 v96, s63, v240
    v_dot2c_f32_bf16 v98, v240, v240
    v_dot2c_f32_bf16 v97, s63, v241
    v_dot2c_f32_bf16 v99, v241, v241
    v_dot2c_f32_bf16 v96, s63, v242
    v_dot2c_f32_bf16 v98, v242, v242
    v_dot2c_f32_bf16 v97, s63, v243
    v_dot2c_f32_bf16 v99, v243, v243
    v_dot2c_f32_bf16 v96, s63, v244
    v_dot2c_f32_bf16 v98, v244, v244
    v_dot2c_f32_bf16 v97, s63, v245
    v_dot2c_f32_bf16 v99, v245, v245
    v_dot2c_f32_bf16 v96, s63, v246
    v_dot2c_f32_bf16 v98, v246, v246
    v_dot2c_f32_bf16 v97, s63, v247
    v_dot2c_f32_bf16 v99, v247, v247
    s_waitcnt vmcnt(7)
    s_mov_b32 s80, 0
L_non_p:
    v_cmp_eq_u32 vcc, 0, v232
    s_nop 0
    s_cbranch_vccz L_non_w
    s_add_u32 s80, s80, 1
    s_cmp_gt_u32 s80, 0x80000
    s_cbranch_scc1 L_non_w
    global_load_dword v232, v234, s[46:47] sc1
    s_waitcnt vmcnt(0)
    s_branch L_non_p
L_non_w:
    v_readfirstlane_b32 s81, v232
    v_mov_b32 v102, v232
    v_mov_b32 v103, v232
    v_mov_b32 v106, v232
    v_mov_b32 v107, v232
    v_mov_b32 v110, v232
    v_mov_b32 v111, v232
    v_mov_b32 v122, v232
    v_mov_b32 v123, v232
    s_waitcnt lgkmcnt(0)
    s_barrier
    ds_read_b64_tr_b16 v[100:101], v236 offset:0
    ds_read_b64_tr_b16 v[104:105], v236 offset:64
    ds_read_b64_tr_b16 v[108:109], v236 offset:128
    ds_read_b64_tr_b16 v[120:121], v236 offset:192
    v_lshlrev_b32 v116, 16, v248
    v_and_b32 v117, s58, v248
    v_add_f32 v96, v96, v97
    v_add_f32 v98, v98, v99
    v_mul_f32 v118, 0xbfb8aa3b, v116
    v_mul_f32 v119, 0xbfb8aa3b, v117
    v_add_f32_dpp v96, v96, v96 quad_perm:[1,0,3,2] row_mask:0xf bank_mask:0xf
    v_add_f32_dpp v98, v98, v98 quad_perm:[1,0,3,2] row_mask:0xf bank_mask:0xf
    v_exp_f32 v118, v118
    v_exp_f32 v119, v119
    v_add_f32_dpp v96, v96, v96 quad_perm:[2,3,0,1] row_mask:0xf bank_mask:0xf
    v_add_f32_dpp v98, v98, v98 quad_perm:[2,3,0,1] row_mask:0xf bank_mask:0xf
    v_add_f32 v118, 1.0, v118
    v_add_f32 v119, 1.0, v119
    v_add_f32_dpp v96, v96, v96 row_half_mirror row_mask:0xf bank_mask:0xf
    v_add_f32_dpp v98, v98, v98 row_half_mirror row_mask:0xf bank_mask:0xf
    v_rcp_f32 v118, v118
    v_rcp_f32 v119, v119
    v_add_f32_dpp v96, v96, v96 row_mirror row_mask:0xf bank_mask:0xf
    v_add_f32_dpp v98, v98, v98 row_mirror row_mask:0xf bank_mask:0xf
    v_mov_b32_e64 v97, v96
    v_mov_b32 v99, v98
    s_waitcnt lgkmcnt(3)
    global_store_dwordx4 v235, v[100:103], s[12:13] sc1
    s_add_u32 s12, s12, 0x40000
    s_addc_u32 s13, s13, 0
    s_waitcnt lgkmcnt(2)
    global_store_dwordx4 v235, v[104:107], s[12:13] sc1
    s_add_u32 s12, s12, 0x40000
    s_addc_u32 s13, s13, 0
    s_waitcnt lgkmcnt(1)
    global_store_dwordx4 v235, v[108:111], s[12:13] sc1
    s_add_u32 s12, s12, 0x40000
    s_addc_u32 s13, s13, 0
    s_waitcnt lgkmcnt(0)
    global_store_dwordx4 v235, v[120:123], s[12:13] sc1
    v_mul_f32 v116, v116, v118
    v_mul_f32 v117, v117, v119
    v_cvt_pk_bf16_f32 v116, v116, v117
    ds_write_b32 v249, v116
    v_permlane16_swap_b32 v96, v97
    v_permlane16_swap_b32 v98, v99
    ds_read_b128 a[32:35], v233 offset:0
    ds_read_b128 a[36:39], v233 offset:32
    ds_read_b128 a[40:43], v233 offset:64
    v_add_f32 v96, v96, v97
    v_add_f32 v98, v98, v99
    v_mul_f32 v96, 0x3b000000, v96
    v_mul_f32 v98, 0x3b000000, v98
    v_fma_f32 v98, -v96, v96, v98
    v_max_f32_e64 v98, 0, v98
    v_add_f32 v98, 0x3727c5ac, v98
    v_rsq_f32 v240, v98
    s_nop 0
    v_mul_f32 v242, v96, v240
    v_mov_b32 v241, v240
    v_mov_b32 v243, v242
    s_nop 0
    v_permlane32_swap_b32 v240, v241
    v_permlane32_swap_b32 v242, v243
    v_cvt_pk_bf16_f32 v242, v242, v243
    v_mov_b32 v243, v232
    s_mov_b64 exec, 1
    global_store_dwordx4 v12, v[240:243], s[24:25] sc1
    s_mov_b64 exec, -1
    s_nop 1
    v_mov_b32 v96, 1.0
    v_mov_b32 v97, 0
    v_pk_mul_f32 v[132:133], v[96:97], v[156:157] op_sel:[0,0] op_sel_hi:[1,0]
    v_perm_b32 v144, v97, v96, s57
    v_and_b32 v140, s58, v96
    v_and_b32 v141, s58, v97
    v_pk_fma_f32 v[132:133], v[96:97], v[158:159], v[132:133] op_sel:[1,0,0] op_sel_hi:[0,0,1] neg_lo:[1,0,0]
    v_pk_add_f32 v[142:143], v[96:97], v[140:141] neg_lo:[0,1] neg_hi:[0,1]
    v_cvt_pk_bf16_f32 v145, v142, v143
    ds_write2st64_b32 v16, v144, v145 offset0:0 offset1:32
    v_pk_mul_f32 v[98:99], v[96:97], v[152:153] op_sel:[0,0] op_sel_hi:[1,0]
    v_perm_b32 v150, v133, v132, s57
    v_and_b32 v146, s58, v132
    v_and_b32 v147, s58, v133
    v_pk_fma_f32 v[98:99], v[96:97], v[154:155], v[98:99] op_sel:[1,0,0] op_sel_hi:[0,0,1] neg_lo:[1,0,0]
    v_pk_add_f32 v[148:149], v[132:133], v[146:147] neg_lo:[0,1] neg_hi:[0,1]
    v_cvt_pk_bf16_f32 v151, v148, v149
    ds_write2st64_b32 v16, v150, v151 offset0:16 offset1:48
    v_pk_mul_f32 v[134:135], v[98:99], v[156:157] op_sel:[0,0] op_sel_hi:[1,0]
    v_perm_b32 v144, v99, v98, s57
    v_and_b32 v140, s58, v98
    v_and_b32 v141, s58, v99
    v_pk_fma_f32 v[134:135], v[98:99], v[158:159], v[134:135] op_sel:[1,0,0] op_sel_hi:[0,0,1] neg_lo:[1,0,0]
    v_pk_add_f32 v[142:143], v[98:99], v[140:141] neg_lo:[0,1] neg_hi:[0,1]
    v_cvt_pk_bf16_f32 v145, v142, v143
    ds_write2st64_b32 v17, v144, v145 offset0:1 offset1:33
    s_nop 0
    s_waitcnt vmcnt(9)
    ds_read_b64_tr_b16 a[48:49], v254 offset:0
    ds_read_b64_tr_b16 a[50:51], v254 offset:256
    ds_read_b64_tr_b16 a[52:53], v254 offset:1024
    ds_read_b64_tr_b16 a[54:55], v254 offset:1280
    ds_read_b64_tr_b16 a[56:57], v254 offset:2048
    ds_read_b64_tr_b16 a[58:59], v254 offset:2304
    v_pk_mul_f32 v[100:101], v[98:99], v[152:153] op_sel:[0,0] op_sel_hi:[1,0]
    v_perm_b32 v150, v135, v134, s57
    v_and_b32 v146, s58, v134
    v_and_b32 v147, s58, v135
    v_pk_fma_f32 v[100:101], v[98:99], v[154:155], v[100:101] op_sel:[1,0,0] op_sel_hi:[0,0,1] neg_lo:[1,0,0]
    v_pk_add_f32 v[148:149], v[134:135], v[146:147] neg_lo:[0,1] neg_hi:[0,1]
    v_cvt_pk_bf16_f32 v151, v148, v149
    ds_write2st64_b32 v17, v150, v151 offset0:17 offset1:49
    v_pk_mul_f32 v[132:133], v[100:101], v[156:157] op_sel:[0,0] op_sel_hi:[1,0]
    v_perm_b32 v144, v101, v100, s57
    v_and_b32 v140, s58, v100
    v_and_b32 v141, s58, v101
    v_pk_fma_f32 v[132:133], v[100:101], v[158:159], v[132:133] op_sel:[1,0,0] op_sel_hi:[0,0,1] neg_lo:[1,0,0]
    v_pk_add_f32 v[142:143], v[100:101], v[140:141] neg_lo:[0,1] neg_hi:[0,1]
    v_cvt_pk_bf16_f32 v145, v142, v143
    ds_write2st64_b32 v18, v144, v145 offset0:2 offset1:34
    s_nop 0
    s_waitcnt lgkmcnt(2)
    v_mfma_f32_32x32x16_bf16 a[64:79], a[32:35], a[48:51], 0
    v_mfma_f32_32x32x16_bf16 a[80:95], a[40:43], a[56:59], 0
    v_mfma_f32_32x32x16_bf16 a[64:79], a[36:39], a[52:55], a[64:79]
    v_pk_mul_f32 v[102:103], v[100:101], v[152:153] op_sel:[0,0] op_sel_hi:[1,0]
    v_perm_b32 v150, v133, v132, s57
    v_and_b32 v146, s58, v132
    v_and_b32 v147, s58, v133
    v_pk_fma_f32 v[102:103], v[100:101], v[154:155], v[102:103] op_sel:[1,0,0] op_sel_hi:[0,0,1] neg_lo:[1,0,0]
    v_pk_add_f32 v[148:149], v[132:133], v[146:147] neg_lo:[0,1] neg_hi:[0,1]
    v_cvt_pk_bf16_f32 v151, v148, v149
    ds_write2st64_b32 v18, v150, v151 offset0:18 offset1:50
    v_pk_mul_f32 v[134:135], v[102:103], v[156:157] op_sel:[0,0] op_sel_hi:[1,0]
    v_perm_b32 v144, v103, v102, s57
    v_and_b32 v140, s58, v102
    v_and_b32 v141, s58, v103
    v_pk_fma_f32 v[134:135], v[102:103], v[158:159], v[134:135] op_sel:[1,0,0] op_sel_hi:[0,0,1] neg_lo:[1,0,0]
    v_pk_add_f32 v[142:143], v[102:103], v[140:141] neg_lo:[0,1] neg_hi:[0,1]
    v_cvt_pk_bf16_f32 v145, v142, v143
    ds_write2st64_b32 v19, v144, v145 offset0:3 offset1:35
    v_pk_mul_f32 v[104:105], v[102:103], v[152:153] op_sel:[0,0] op_sel_hi:[1,0]
    v_perm_b32 v150, v135, v134, s57
    v_and_b32 v146, s58, v134
    v_and_b32 v147, s58, v135
    v_pk_fma_f32 v[104:105], v[102:103], v[154:155], v[104:105] op_sel:[1,0,0] op_sel_hi:[0,0,1] neg_lo:[1,0,0]
    v_pk_add_f32 v[148:149], v[134:135], v[146:147] neg_lo:[0,1] neg_hi:[0,1]
    v_cvt_pk_bf16_f32 v151, v148, v149
    ds_write2st64_b32 v19, v150, v151 offset0:19 offset1:51
    ds_write_b32 v249, a80 offset:2048
    ds_write_b32 v249, a64 offset:1024
    s_waitcnt lgkmcnt(0)
    s_barrier
    ds_read_b32 v244, v252 offset:0
    ds_read_b32 v245, v252 offset:256
    ds_read_b32 v246, v252 offset:512
    ds_read_b32 v247, v252 offset:768
    v_pk_mul_f32 v[132:133], v[104:105], v[156:157] op_sel:[0,0] op_sel_hi:[1,0]
    v_perm_b32 v144, v105, v104, s57
    v_and_b32 v140, s58, v104
    v_and_b32 v141, s58, v105
    v_pk_fma_f32 v[132:133], v[104:105], v[158:159], v[132:133] op_sel:[1,0,0] op_sel_hi:[0,0,1] neg_lo:[1,0,0]
    v_pk_add_f32 v[142:143], v[104:105], v[140:141] neg_lo:[0,1] neg_hi:[0,1]
    v_cvt_pk_bf16_f32 v145, v142, v143
    ds_write2st64_b32 v20, v144, v145 offset0:4 offset1:36
    v_pk_mul_f32 v[106:107], v[104:105], v[152:153] op_sel:[0,0] op_sel_hi:[1,0]
    v_perm_b32 v150, v133, v132, s57
    v_and_b32 v146, s58, v132
    v_and_b32 v147, s58, v133
    v_pk_fma_f32 v[106:107], v[104:105], v[154:155], v[106:107] op_sel:[1,0,0] op_sel_hi:[0,0,1] neg_lo:[1,0,0]
    v_pk_add_f32 v[148:149], v[132:133], v[146:147] neg_lo:[0,1] neg_hi:[0,1]
    v_cvt_pk_bf16_f32 v151, v148, v149
    ds_write2st64_b32 v20, v150, v151 offset0:20 offset1:52
    s_waitcnt lgkmcnt(2)
    s_cmp_ge_u32 s50, 2
    s_cbranch_scc1 L_cm2
    v_add_f32 v244, v244, v245
    v_add_f32 v246, v246, v247
    v_add_f32 v244, v244, v246
    v_mov_b32 v245, v232
    global_store_dwordx2 v253, v[244:245], s[16:17] sc1
    s_branch L_cm3
L_cm2:
    v_and_b32 v246, 15, v1
    s_lshl_b32 s75, s2, 6
    v_lshl_add_u32 v246, v246, 2, s75
    global_store_dword v246, v12, s[14:15] sc1
L_cm3:
    v_pk_mul_f32 v[134:135], v[106:107], v[156:157] op_sel:[0,0] op_sel_hi:[1,0]
    v_perm_b32 v144, v107, v106, s57
    v_and_b32 v140, s58, v106
    v_and_b32 v141, s58, v107
    v_pk_fma_f32 v[134:135], v[106:107], v[158:159], v[134:135] op_sel:[1,0,0] op_sel_hi:[0,0,1] neg_lo:[1,0,0]
    v_pk_add_f32 v[142:143], v[106:107], v[140:141] neg_lo:[0,1] neg_hi:[0,1]
    v_cvt_pk_bf16_f32 v145, v142, v143
    ds_write2st64_b32 v21, v144, v145 offset0:5 offset1:37
    v_pk_mul_f32 v[108:109], v[106:107], v[152:153] op_sel:[0,0] op_sel_hi:[1,0]
    v_perm_b32 v150, v135, v134, s57
    v_and_b32 v146, s58, v134
    v_and_b32 v147, s58, v135
    v_pk_fma_f32 v[108:109], v[106:107], v[154:155], v[108:109] op_sel:[1,0,0] op_sel_hi:[0,0,1] neg_lo:[1,0,0]
    v_pk_add_f32 v[148:149], v[134:135], v[146:147] neg_lo:[0,1] neg_hi:[0,1]
    v_cvt_pk_bf16_f32 v151, v148, v149
    ds_write2st64_b32 v21, v150, v151 offset0:21 offset1:53
    v_pk_mul_f32 v[132:133], v[108:109], v[156:157] op_sel:[0,0] op_sel_hi:[1,0]
    v_perm_b32 v144, v109, v108, s57
    v_and_b32 v140, s58, v108
    v_and_b32 v141, s58, v109
    v_pk_fma_f32 v[132:133], v[108:109], v[158:159], v[132:133] op_sel:[1,0,0] op_sel_hi:[0,0,1] neg_lo:[1,0,0]
    v_pk_add_f32 v[142:143], v[108:109], v[140:141] neg_lo:[0,1] neg_hi:[0,1]
    v_cvt_pk_bf16_f32 v145, v142, v143
    ds_write2st64_b32 v22, v144, v145 offset0:6 offset1:38
    v_pk_mul_f32 v[110:111], v[108:109], v[152:153] op_sel:[0,0] op_sel_hi:[1,0]
    v_perm_b32 v150, v133, v132, s57
    v_and_b32 v146, s58, v132
    v_and_b32 v147, s58, v133
    v_pk_fma_f32 v[110:111], v[108:109], v[154:155], v[110:111] op_sel:[1,0,0] op_sel_hi:[0,0,1] neg_lo:[1,0,0]
    v_pk_add_f32 v[148:149], v[132:133], v[146:147] neg_lo:[0,1] neg_hi:[0,1]
    v_cvt_pk_bf16_f32 v151, v148, v149
    ds_write2st64_b32 v22, v150, v151 offset0:22 offset1:54
    v_pk_mul_f32 v[134:135], v[110:111], v[156:157] op_sel:[0,0] op_sel_hi:[1,0]
    v_perm_b32 v144, v111, v110, s57
    v_and_b32 v140, s58, v110
    v_and_b32 v141, s58, v111
    v_pk_fma_f32 v[134:135], v[110:111], v[158:159], v[134:135] op_sel:[1,0,0] op_sel_hi:[0,0,1] neg_lo:[1,0,0]
    v_pk_add_f32 v[142:143], v[110:111], v[140:141] neg_lo:[0,1] neg_hi:[0,1]
    v_cvt_pk_bf16_f32 v145, v142, v143
    ds_write2st64_b32 v23, v144, v145 offset0:7 offset1:39
    v_pk_mul_f32 v[112:113], v[110:111], v[152:153] op_sel:[0,0] op_sel_hi:[1,0]
    v_perm_b32 v150, v135, v134, s57
    v_and_b32 v146, s58, v134
    v_and_b32 v147, s58, v135
    v_pk_fma_f32 v[112:113], v[110:111], v[154:155], v[112:113] op_sel:[1,0,0] op_sel_hi:[0,0,1] neg_lo:[1,0,0]
    v_pk_add_f32 v[148:149], v[134:135], v[146:147] neg_lo:[0,1] neg_hi:[0,1]
    v_cvt_pk_bf16_f32 v151, v148, v149
    ds_write2st64_b32 v23, v150, v151 offset0:23 offset1:55
    v_pk_mul_f32 v[132:133], v[112:113], v[156:157] op_sel:[0,0] op_sel_hi:[1,0]
    v_perm_b32 v144, v113, v112, s57
    v_and_b32 v140, s58, v112
    v_and_b32 v141, s58, v113
    v_pk_fma_f32 v[132:133], v[112:113], v[158:159], v[132:133] op_sel:[1,0,0] op_sel_hi:[0,0,1] neg_lo:[1,0,0]
    v_pk_add_f32 v[142:143], v[112:113], v[140:141] neg_lo:[0,1] neg_hi:[0,1]
    v_cvt_pk_bf16_f32 v145, v142, v143
    ds_write2st64_b32 v24, v144, v145 offset0:8 offset1:40
    v_pk_mul_f32 v[114:115], v[112:113], v[152:153] op_sel:[0,0] op_sel_hi:[1,0]
    v_perm_b32 v150, v133, v132, s57
    v_and_b32 v146, s58, v132
    v_and_b32 v147, s58, v133
    v_pk_fma_f32 v[114:115], v[112:113], v[154:155], v[114:115] op_sel:[1,0,0] op_sel_hi:[0,0,1] neg_lo:[1,0,0]
    v_pk_add_f32 v[148:149], v[132:133], v[146:147] neg_lo:[0,1] neg_hi:[0,1]
    v_cvt_pk_bf16_f32 v151, v148, v149
    ds_write2st64_b32 v24, v150, v151 offset0:24 offset1:56
    v_pk_mul_f32 v[134:135], v[114:115], v[156:157] op_sel:[0,0] op_sel_hi:[1,0]
    v_perm_b32 v144, v115, v114, s57
    v_and_b32 v140, s58, v114
    v_and_b32 v141, s58, v115
    v_pk_fma_f32 v[134:135], v[114:115], v[158:159], v[134:135] op_sel:[1,0,0] op_sel_hi:[0,0,1] neg_lo:[1,0,0]
    v_pk_add_f32 v[142:143], v[114:115], v[140:141] neg_lo:[0,1] neg_hi:[0,1]
    v_cvt_pk_bf16_f32 v145, v142, v143
    ds_write2st64_b32 v25, v144, v145 offset0:9 offset1:41
    v_pk_mul_f32 v[116:117], v[114:115], v[152:153] op_sel:[0,0] op_sel_hi:[1,0]
    v_perm_b32 v150, v135, v134, s57
    v_and_b32 v146, s58, v134
    v_and_b32 v147, s58, v135
    v_pk_fma_f32 v[116:117], v[114:115], v[154:155], v[116:117] op_sel:[1,0,0] op_sel_hi:[0,0,1] neg_lo:[1,0,0]
    v_pk_add_f32 v[148:149], v[134:135], v[146:147] neg_lo:[0,1] neg_hi:[0,1]
    v_cvt_pk_bf16_f32 v151, v148, v149
    ds_write2st64_b32 v25, v150, v151 offset0:25 offset1:57
    v_pk_mul_f32 v[132:133], v[116:117], v[156:157] op_sel:[0,0] op_sel_hi:[1,0]
    v_perm_b32 v144, v117, v116, s57
    v_and_b32 v140, s58, v116
    v_and_b32 v141, s58, v117
    v_pk_fma_f32 v[132:133], v[116:117], v[158:159], v[132:133] op_sel:[1,0,0] op_sel_hi:[0,0,1] neg_lo:[1,0,0]
    v_pk_add_f32 v[142:143], v[116:117], v[140:141] neg_lo:[0,1] neg_hi:[0,1]
    v_cvt_pk_bf16_f32 v145, v142, v143
    ds_write2st64_b32 v26, v144, v145 offset0:10 offset1:42
    s_waitcnt vmcnt(6)
    s_barrier
    ds_read_b64_tr_b16 a[0:1], v224
    ds_read_b64_tr_b16 a[2:3], v228
    ds_read_b64_tr_b16 a[4:5], v225
    ds_read_b64_tr_b16 a[6:7], v229
    ds_read_b64_tr_b16 a[8:9], v226
    ds_read_b64_tr_b16 a[10:11], v230
    ds_read_b64_tr_b16 a[12:13], v227
    ds_read_b64_tr_b16 a[14:15], v231
    s_waitcnt lgkmcnt(0)
    s_cmp_ge_u32 s2, 224
    s_cbranch_scc1 L_pk_no
    global_store_dwordx4 v255, a[0:3], s[70:71] sc1
    global_store_dwordx4 v237, a[4:7], s[70:71] sc1
    global_store_dwordx4 v238, a[8:11], s[70:71] sc1
    global_store_dwordx4 v239, a[12:15], s[70:71] sc1
L_pk_no:
    v_pk_mul_f32 v[118:119], v[116:117], v[152:153] op_sel:[0,0] op_sel_hi:[1,0]
    v_perm_b32 v150, v133, v132, s57
    v_and_b32 v146, s58, v132
    v_and_b32 v147, s58, v133
    v_pk_fma_f32 v[118:119], v[116:117], v[154:155], v[118:119] op_sel:[1,0,0] op_sel_hi:[0,0,1] neg_lo:[1,0,0]
    v_pk_add_f32 v[148:149], v[132:133], v[146:147] neg_lo:[0,1] neg_hi:[0,1]
    v_cvt_pk_bf16_f32 v151, v148, v149
    ds_write2st64_b32 v26, v150, v151 offset0:26 offset1:58
    v_pk_mul_f32 v[134:135], v[118:119], v[156:157] op_sel:[0,0] op_sel_hi:[1,0]
    v_perm_b32 v144, v119, v118, s57
    v_and_b32 v140, s58, v118
    v_and_b32 v141, s58, v119
    v_pk_fma_f32 v[134:135], v[118:119], v[158:159], v[134:135] op_sel:[1,0,0] op_sel_hi:[0,0,1] neg_lo:[1,0,0]
    v_pk_add_f32 v[142:143], v[118:119], v[140:141] neg_lo:[0,1] neg_hi:[0,1]
    v_cvt_pk_bf16_f32 v145, v142, v143
    ds_write2st64_b32 v27, v144, v145 offset0:11 offset1:43
    v_pk_mul_f32 v[120:121], v[118:119], v[152:153] op_sel:[0,0] op_sel_hi:[1,0]
    v_perm_b32 v150, v135, v134, s57
    v_and_b32 v146, s58, v134
    v_and_b32 v147, s58, v135
    v_pk_fma_f32 v[120:121], v[118:119], v[154:155], v[120:121] op_sel:[1,0,0] op_sel_hi:[0,0,1] neg_lo:[1,0,0]
    v_pk_add_f32 v[148:149], v[134:135], v[146:147] neg_lo:[0,1] neg_hi:[0,1]
    v_cvt_pk_bf16_f32 v151, v148, v149
    ds_write2st64_b32 v27, v150, v151 offset0:27 offset1:59
    v_pk_mul_f32 v[132:133], v[120:121], v[156:157] op_sel:[0,0] op_sel_hi:[1,0]
    v_perm_b32 v144, v121, v120, s57
    v_and_b32 v140, s58, v120
    v_and_b32 v141, s58, v121
    v_pk_fma_f32 v[132:133], v[120:121], v[158:159], v[132:133] op_sel:[1,0,0] op_sel_hi:[0,0,1] neg_lo:[1,0,0]
    v_pk_add_f32 v[142:143], v[120:121], v[140:141] neg_lo:[0,1] neg_hi:[0,1]
    v_cvt_pk_bf16_f32 v145, v142, v143
    ds_write2st64_b32 v28, v144, v145 offset0:12 offset1:44
    v_pk_mul_f32 v[122:123], v[120:121], v[152:153] op_sel:[0,0] op_sel_hi:[1,0]
    v_perm_b32 v150, v133, v132, s57
    v_and_b32 v146, s58, v132
    v_and_b32 v147, s58, v133
    v_pk_fma_f32 v[122:123], v[120:121], v[154:155], v[122:123] op_sel:[1,0,0] op_sel_hi:[0,0,1] neg_lo:[1,0,0]
    v_pk_add_f32 v[148:149], v[132:133], v[146:147] neg_lo:[0,1] neg_hi:[0,1]
    v_cvt_pk_bf16_f32 v151, v148, v149
    ds_write2st64_b32 v28, v150, v151 offset0:28 offset1:60
    v_pk_mul_f32 v[134:135], v[122:123], v[156:157] op_sel:[0,0] op_sel_hi:[1,0]
    v_perm_b32 v144, v123, v122, s57
    v_and_b32 v140, s58, v122
    v_and_b32 v141, s58, v123
    v_pk_fma_f32 v[134:135], v[122:123], v[158:159], v[134:135] op_sel:[1,0,0] op_sel_hi:[0,0,1] neg_lo:[1,0,0]
    v_pk_add_f32 v[142:143], v[122:123], v[140:141] neg_lo:[0,1] neg_hi:[0,1]
    v_cvt_pk_bf16_f32 v145, v142, v143
    ds_write2st64_b32 v29, v144, v145 offset0:13 offset1:45
    v_pk_mul_f32 v[124:125], v[122:123], v[152:153] op_sel:[0,0] op_sel_hi:[1,0]
    v_perm_b32 v150, v135, v134, s57
    v_and_b32 v146, s58, v134
    v_and_b32 v147, s58, v135
    v_pk_fma_f32 v[124:125], v[122:123], v[154:155], v[124:125] op_sel:[1,0,0] op_sel_hi:[0,0,1] neg_lo:[1,0,0]
    v_pk_add_f32 v[148:149], v[134:135], v[146:147] neg_lo:[0,1] neg_hi:[0,1]
    v_cvt_pk_bf16_f32 v151, v148, v149
    ds_write2st64_b32 v29, v150, v151 offset0:29 offset1:61
    v_pk_mul_f32 v[132:133], v[124:125], v[156:157] op_sel:[0,0] op_sel_hi:[1,0]
    v_perm_b32 v144, v125, v124, s57
    v_and_b32 v140, s58, v124
    v_and_b32 v141, s58, v125
    v_pk_fma_f32 v[132:133], v[124:125], v[158:159], v[132:133] op_sel:[1,0,0] op_sel_hi:[0,0,1] neg_lo:[1,0,0]
    v_pk_add_f32 v[142:143], v[124:125], v[140:141] neg_lo:[0,1] neg_hi:[0,1]
    v_cvt_pk_bf16_f32 v145, v142, v143
    ds_write2st64_b32 v30, v144, v145 offset0:14 offset1:46
    v_pk_mul_f32 v[126:127], v[124:125], v[152:153] op_sel:[0,0] op_sel_hi:[1,0]
    v_perm_b32 v150, v133, v132, s57
    v_and_b32 v146, s58, v132
    v_and_b32 v147, s58, v133
    v_pk_fma_f32 v[126:127], v[124:125], v[154:155], v[126:127] op_sel:[1,0,0] op_sel_hi:[0,0,1] neg_lo:[1,0,0]
    v_pk_add_f32 v[148:149], v[132:133], v[146:147] neg_lo:[0,1] neg_hi:[0,1]
    v_cvt_pk_bf16_f32 v151, v148, v149
    ds_write2st64_b32 v30, v150, v151 offset0:30 offset1:62
    v_pk_mul_f32 v[134:135], v[126:127], v[156:157] op_sel:[0,0] op_sel_hi:[1,0]
    v_perm_b32 v144, v127, v126, s57
    v_and_b32 v140, s58, v126
    v_and_b32 v141, s58, v127
    v_pk_fma_f32 v[134:135], v[126:127], v[158:159], v[134:135] op_sel:[1,0,0] op_sel_hi:[0,0,1] neg_lo:[1,0,0]
    v_pk_add_f32 v[142:143], v[126:127], v[140:141] neg_lo:[0,1] neg_hi:[0,1]
    v_cvt_pk_bf16_f32 v145, v142, v143
    ds_write2st64_b32 v31, v144, v145 offset0:15 offset1:47
    v_perm_b32 v150, v135, v134, s57
    v_and_b32_e64 v146, s58, v134
    v_and_b32 v147, s58, v135
    v_pk_add_f32 v[148:149], v[134:135], v[146:147] neg_lo:[0,1] neg_hi:[0,1]
    v_cvt_pk_bf16_f32 v151, v148, v149
    ds_write2st64_b32 v31, v150, v151 offset0:31 offset1:63
    s_waitcnt lgkmcnt(0)
    ds_read_b128 v[96:99], v32
    ds_read_b128 v[100:103], v32 offset:8192
    ds_read_b128 v[104:107], v33
    ds_read_b128 v[108:111], v33 offset:8192
    ds_read_b128 v[112:115], v34
    ds_read_b128 v[116:119], v34 offset:8192
    ds_read_b128 v[120:123], v35
    ds_read_b128 v[124:127], v35 offset:8192
    ds_read_b128 v[128:131], v36
    ds_read_b128 v[132:135], v36 offset:8192
    ds_read_b128 v[136:139], v37
    ds_read_b128 v[140:143], v37 offset:8192
    ds_read_b128 v[144:147], v38
    ds_read_b128 v[148:151], v38 offset:8192
    ds_read_b128 v[152:155], v39
    ds_read_b128 v[156:159], v39 offset:8192
    s_waitcnt lgkmcnt(14)
    v_mfma_f32_32x32x16_bf16 v[224:239], v[160:163], v[96:99], 0
    v_lshrrev_b32 v7, 2, v1
    v_and_b32 v8, 3, v1
    v_lshlrev_b32 v56, 4, v59
    v_sub_u32 v56, 2047, v56
    v_cvt_f32_u32 v57, v56
    v_mov_b32 v56, v57
    v_mfma_f32_32x32x16_bf16 v[224:239], v[160:163], v[100:103], v[224:239]
    v_lshlrev_b32_e64 v16, 10, v7
    v_lshl_add_u32 v16, v8, 4, v16
    v_cvt_pk_bf16_f32 v56, v56, 0
    v_lshrrev_b32 v77, 5, v56
    v_add_u32 v56, v56, v77
    v_lshl_add_u32 v60, v56, 2, s56
    v_mfma_f32_32x32x16_bf16 v[224:239], v[192:195], v[96:99], v[224:239]
    s_lshl_b32 s60, s50, 16
    s_lshr_b32 s61, s34, 4
    s_lshl_b32 s61, s61, 18
    s_add_u32 s60, s60, s61
    s_and_b32 s61, s34, 15
    s_lshl_b32 s61, s61, 6
    s_add_u32 s60, s60, s61
    s_add_u32 s62, s48, s60
    s_addc_u32 s63, s49, 0
    v_add_f32 v56, 0xbf800000, v57
    v_cvt_pk_bf16_f32 v56, v56, 0
    v_lshrrev_b32_e64 v77, 5, v56
    v_add_u32 v56, v56, v77
    s_waitcnt lgkmcnt(12)
    v_mfma_f32_32x32x16_bf16 v[224:239], v[164:167], v[104:107], v[224:239]
    v_add_u32 v17, 0x4000, v16
    v_add_u32 v18, 0x8000, v16
    v_lshl_add_u32 v61, v56, 2, s56
    v_add_f32_e64 v56, 0xc0000000, v57
    v_cvt_pk_bf16_f32 v56, v56, 0
    v_lshrrev_b32_e64 v77, 5, v56
    v_mfma_f32_32x32x16_bf16 v[224:239], v[164:167], v[108:111], v[224:239]
    v_add_u32 v19, 0xc000, v16
    v_and_b32 v10, 1, v8
    v_add_u32 v56, v56, v77
    v_lshl_add_u32 v62, v56, 2, s56
    v_add_f32 v56, 0xc0400000, v57
    v_cvt_pk_bf16_f32 v56, v56, 0
    v_mfma_f32_32x32x16_bf16 v[224:239], v[196:199], v[104:107], v[224:239]
    v_lshlrev_b32_e64 v24, 6, v7
    v_lshl_add_u32 v24, v10, 5, v24
    v_lshrrev_b32 v77, 5, v56
    v_add_u32 v56, v56, v77
    v_lshl_add_u32 v63, v56, 2, s56
    v_add_f32 v56, 0xc0800000, v57
    s_waitcnt lgkmcnt(10)
    v_mfma_f32_32x32x16_bf16 v[224:239], v[168:171], v[112:115], v[224:239]
    v_lshrrev_b32_e64 v9, 1, v8
    v_lshl_add_u32 v24, v9, 4, v24
    v_cvt_pk_bf16_f32 v56, v56, 0
    v_lshrrev_b32 v77, 5, v56
    v_add_u32 v56, v56, v77
    v_lshl_add_u32 v64, v56, 2, s56
    v_mfma_f32_32x32x16_bf16 v[224:239], v[168:171], v[116:119], v[224:239]
    s_lshl_b32 s60, s50, 12
    s_add_u32 s60, s60, 0x800000
    s_add_u32 s24, s48, s60
    s_addc_u32 s25, s49, 0
    v_lshlrev_b32 v21, 3, v1
    v_add_f32 v56, 0xc0a00000, v57
    v_cvt_pk_bf16_f32 v56, v56, 0
    v_lshrrev_b32_e64 v77, 5, v56
    v_add_u32 v56, v56, v77
    v_mfma_f32_32x32x16_bf16 v[224:239], v[200:203], v[112:115], v[224:239]
    s_lshl_b32 s60, s34, 9
    s_add_u32 s60, s60, 0x820000
    s_add_u32 s64, s48, s60
    s_addc_u32 s65, s49, 0
    s_or_b32 s66, s55, 0x4000
    v_lshl_add_u32 v65, v56, 2, s56
    v_add_f32 v56, 0xc0c00000, v57
    v_cvt_pk_bf16_f32 v56, v56, 0
    v_lshrrev_b32 v77, 5, v56
    s_waitcnt lgkmcnt(8)
    v_mfma_f32_32x32x16_bf16 v[224:239], v[172:175], v[120:123], v[224:239]
    v_lshl_add_u32 v3, v1, 4, s66
    s_mul_i32 s55, s52, 21120
    s_add_u32 s55, s55, 0
    v_add_u32 v56, v56, v77
    v_lshl_add_u32 v66, v56, 2, s56
    v_add_f32 v56, 0xc0e00000, v57
    v_cvt_pk_bf16_f32 v56, v56, 0
    v_mfma_f32_32x32x16_bf16 v[224:239], v[172:175], v[124:127], v[224:239]
    v_lshl_add_u32 v2, v59, 5, s55
    global_load_dwordx4 v[240:243], v16, s[62:63] sc1
    v_lshrrev_b32 v77, 5, v56
    v_add_u32 v56, v56, v77
    v_lshl_add_u32 v67, v56, 2, s56
    v_add_f32 v56, 0xc1000000, v57
    v_mfma_f32_32x32x16_bf16 v[224:239], v[204:207], v[120:123], v[224:239]
    global_load_dwordx4 v[244:247], v17, s[62:63] sc1
    global_load_dwordx4 v[248:251], v18, s[62:63] sc1
    v_cvt_pk_bf16_f32 v56, v56, 0
    v_lshrrev_b32_e64 v77, 5, v56
    v_add_u32 v56, v56, v77
    v_lshl_add_u32 v68, v56, 2, s56
    s_waitcnt lgkmcnt(6)
    v_mfma_f32_32x32x16_bf16 v[224:239], v[176:179], v[128:131], v[224:239]
    global_load_dwordx4 v[252:255], v19, s[62:63] sc1
    global_load_dwordx2 v[22:23], v21, s[64:65] sc1
    v_add_f32 v56, 0xc1100000, v57
    v_cvt_pk_bf16_f32 v56, v56, 0
    v_lshrrev_b32 v77, 5, v56
    v_add_u32 v56, v56, v77
    v_mfma_f32_32x32x16_bf16 v[224:239], v[176:179], v[132:135], v[224:239]
    global_load_dwordx4 v[80:83], v24, s[24:25] offset:0 sc1
    global_load_dwordx4 v[84:87], v24, s[24:25] offset:1024 sc1
    v_lshl_add_u32 v69, v56, 2, s56
    v_add_f32 v56, 0xc1200000, v57
    v_cvt_pk_bf16_f32 v56, v56, 0
    v_lshrrev_b32_e64 v77, 5, v56
    v_mfma_f32_32x32x16_bf16 v[224:239], v[208:211], v[128:131], v[224:239]
    global_load_dwordx4 v[88:91], v24, s[24:25] offset:2048 sc1
    global_load_dwordx4 v[92:95], v24, s[24:25] offset:3072 sc1
    v_add_u32_e64 v56, v56, v77
    v_lshl_add_u32 v70, v56, 2, s56
    v_add_f32 v56, 0xc1300000, v57
    v_cvt_pk_bf16_f32 v56, v56, 0
    s_waitcnt lgkmcnt(4)
    v_mfma_f32_32x32x16_bf16 v[224:239], v[180:183], v[136:139], v[224:239]
    v_lshrrev_b32 v77, 5, v56
    v_add_u32_e64 v56, v56, v77
    v_lshl_add_u32 v71, v56, 2, s56
    v_add_f32 v56, 0xc1400000, v57
    v_mfma_f32_32x32x16_bf16 v[224:239], v[180:183], v[140:143], v[224:239]
    v_cvt_pk_bf16_f32 v56, v56, 0
    v_lshrrev_b32 v77, 5, v56
    v_add_u32 v56, v56, v77
    v_lshl_add_u32 v72, v56, 2, s56
    v_mfma_f32_32x32x16_bf16 v[224:239], v[212:215], v[136:139], v[224:239]
    v_add_f32 v56, 0xc1500000, v57
    v_cvt_pk_bf16_f32 v56, v56, 0
    v_lshrrev_b32_e64 v77, 5, v56
    v_add_u32 v56, v56, v77
    s_waitcnt lgkmcnt(2)
    v_mfma_f32_32x32x16_bf16 v[224:239], v[184:187], v[144:147], v[224:239]
    v_lshl_add_u32 v73, v56, 2, s56
    v_add_f32 v56, 0xc1600000, v57
    v_cvt_pk_bf16_f32 v56, v56, 0
    v_lshrrev_b32_e64 v77, 5, v56
    v_mfma_f32_32x32x16_bf16 v[224:239], v[184:187], v[148:151], v[224:239]
    v_add_u32_e64 v56, v56, v77
    v_lshl_add_u32 v74, v56, 2, s56
    v_add_f32 v56, 0xc1700000, v57
    v_max_f32_e64 v56, 0.5, v56
    v_mfma_f32_32x32x16_bf16 v[224:239], v[216:219], v[144:147], v[224:239]
    v_cvt_pk_bf16_f32 v56, v56, 0
    v_lshrrev_b32_e64 v77, 5, v56
    v_add_u32 v56, v56, v77
    v_lshl_add_u32 v75, v56, 2, s56
    s_waitcnt lgkmcnt(0)
    v_mfma_f32_32x32x16_bf16 v[224:239], v[188:191], v[152:155], v[224:239]
    v_add_f32 v56, 0xc1800000, v57
    v_max_f32_e64 v56, 0.5, v56
    v_cvt_pk_bf16_f32 v56, v56, 0
    v_lshrrev_b32_e64 v77, 5, v56
    v_mfma_f32_32x32x16_bf16 v[224:239], v[188:191], v[156:159], v[224:239]
    v_add_u32_e64 v56, v56, v77
    v_lshl_add_u32 v76, v56, 2, s56
    v_mfma_f32_32x32x16_bf16 v[224:239], v[220:223], v[152:155], v[224:239]
    s_nop 7
    s_nop 3
    s_bitcmp1_b32 s50, 0
    s_cbranch_scc0 L_kg_a
    ds_write_b128 v3, v[224:227] offset:0
    ds_write_b128 v3, v[228:231] offset:1024
    ds_write_b128 v3, v[232:235] offset:2048
    s_waitcnt lgkmcnt(0)
L_kg_a:
    s_barrier
    s_cbranch_scc1 L_kg_b
    ds_read_b128 v[96:99], v3 offset:0
    ds_read_b128 v[100:103], v3 offset:1024
    ds_read_b128 v[104:107], v3 offset:2048
    s_waitcnt lgkmcnt(0)
    v_pk_add_f32 v[96:97], v[96:97], v[224:225]
    v_pk_add_f32 v[98:99], v[98:99], v[226:227]
    v_pk_add_f32 v[100:101], v[100:101], v[228:229]
    v_pk_add_f32 v[102:103], v[102:103], v[230:231]
    v_pk_add_f32 v[104:105], v[104:105], v[232:233]
    v_pk_add_f32 v[106:107], v[106:107], v[234:235]
    ds_write_b32 v44, v96
    ds_write_b32 v45, v97
    ds_write_b32 v46, v98
    ds_write_b32 v47, v99
    ds_write_b32 v48, v100
    ds_write_b32 v49, v101
    ds_write_b32 v50, v102
    ds_write_b32 v51, v103
    ds_write_b32 v52, v104
    ds_write_b32 v53, v105
    ds_write_b32 v54, v106
    ds_write_b32 v55, v107
    s_waitcnt lgkmcnt(0)
L_kg_b:
    s_waitcnt vmcnt(9)
    s_barrier
    s_cmp_lg_u32 s50, 1
    s_cbranch_scc1 L_fp_s
    s_lshl_b32 s80, s2, 2
    s_add_u32 s80, s80, 0x6000
    v_lshl_add_u32 v28, v1, 10, s80
    v_mov_b32 v29, s81
    s_mov_b64 exec, 255
    global_store_dword v28, v29, s[14:15] sc1
    s_mov_b64 exec, -1
L_fp_s:
    v_cmp_eq_u32 vcc, 127, v59
    ds_read_b32 v96, v60
    ds_read_b32 v97, v61
    ds_read_b32 v98, v62
    ds_read_b32 v99, v63
    ds_read_b32 v100, v64
    ds_read_b32 v101, v65
    ds_read_b32 v102, v66
    ds_read_b32 v103, v67
    ds_read_b32 v104, v68
    ds_read_b32 v105, v69
    ds_read_b32 v106, v70
    ds_read_b32 v107, v71
    ds_read_b32 v108, v72
    ds_read_b32 v109, v73
    ds_read_b32 v110, v74
    ds_read_b32 v111, v75
    ds_read_b32 v112, v76
    s_and_b32 s54, s50, 1
    v_lshlrev_b32 v11, 4, v1
    v_and_b32_e64 v5, 15, v1
    v_lshrrev_b32 v6, 4, v1
    s_mul_i32 s59, s54, 4160
    s_add_u32 s59, s59, s55
    v_lshl_add_u32 v14, v5, 2, s59
    ds_write_b32 v14, v12 offset:4096
    v_lshl_add_u32 v14, v1, 3, s55
    ds_write_b64 v14, v[12:13] offset:8320
    v_lshlrev_b32_e64 v15, 3, v10
    v_lshl_add_u32 v15, v7, 4, v15
    s_lshl_b32 s60, s50, 10
    v_add_u32 v15, s60, v15
    v_mul_u32_u24 v20, 21120, v9
    v_add_u32_e64 v20, v20, v15
    v_lshl_add_u32 v25, v9, 12, v15
    s_lshl_b32 s76, s54, 10
    s_add_u32 s77, s76, s55
    v_lshlrev_b32_e64 v15, 5, v5
    v_lshl_add_u32 v15, v6, 3, v15
    v_add_u32 v193, s77, v15
    s_lshl_b32 s77, s52, 12
    s_add_u32 s76, s76, s77
    v_add_u32 v202, s76, v15
    v_lshlrev_b32_e64 v15, 5, v5
    v_lshl_add_u32 v15, v6, 4, v15
    s_lshl_b32 s77, s54, 8
    s_sub_u32 s77, s55, s77
    s_add_u32 s78, s77, 8608
    v_add_u32 v192, s78, v15
    v_lshlrev_b32 v15, 3, v6
    v_sub_u32 v15, v15, v5
    v_add_u32 v15, 15, v15
    v_and_b32_e64 v194, 1, v15
    v_mul_u32_u24 v194, 4160, v194
    v_and_b32_e64 v15, -2, v15
    v_lshl_add_u32 v15, v15, 1, v194
    s_add_u32 s78, s77, 256
    v_add_u32_e64 v197, s78, v15
    v_add_u32 v194, 3072, v197
    v_add_u32 v195, 2048, v197
    v_add_u32 v196, 1024, v197
    s_lshl_b32 s77, s54, 12
    s_add_u32 s78, s77, s55
    v_add_u32_e64 v198, s78, v11
    s_xor_b32 s77, s77, 0x1000
    s_add_u32 s78, s77, s55
    v_add_u32 v199, s78, v11
    v_and_b32 v15, 1, v6
    v_lshlrev_b32 v15, 3, v15
    v_lshrrev_b32 v200, 1, v5
    v_add_u32 v15, v15, v200
    v_lshlrev_b32 v200, 15, v15
    v_and_b32 v15, 1, v5
    v_lshl_add_u32 v200, v15, 5, v200
    v_lshrrev_b32 v15, 1, v6
    v_lshl_add_u32 v200, v15, 4, v200
    v_add_u32 v201, 0x100000, v200
    s_lshl_b32 s60, s54, 19
    s_lshl_b32 s61, s53, 6
    s_add_u32 s60, s60, s61
    s_add_u32 s66, s60, 0xd00000
    s_add_u32 s66, s48, s66
    s_addc_u32 s67, s49, 0
    s_add_u32 s68, s60, 0xb00000
    s_add_u32 s68, s48, s68
    s_addc_u32 s69, s49, 0
    s_lshl_b32 s60, s6, 15
    s_add_u32 s26, s60, 0x1800000
    s_add_u32 s26, s48, s26
    s_addc_u32 s27, s49, 0
    s_lshl_b32 s77, s30, 16
    s_and_b32 s74, s30, 0xffff0000
    s_cmp_eq_u32 s52, 0
    s_cselect_b32 s74, s77, s74
    v_bfe_u32 v4, v1, 3, 1
    v_cvt_f32_u32_e64 v4, v4
    v_cmp_gt_u32 vcc, 32, v1
    s_nop 1
    v_cndmask_b32 v4, 0, v4, vcc
    s_lshl_b32 s60, s34, 4
    s_add_u32 s18, s60, 0x860000
    s_add_u32 s18, s48, s18
    s_addc_u32 s19, s49, 0
    s_and_b32 s60, s4, 7
    s_mul_i32 s60, s60, 229376
    s_mul_i32 s61, s50, 28672
    s_add_u32 s60, s60, s61
    s_add_u32 s32, s60, 0x900000
    s_add_u32 s32, s48, s32
    s_addc_u32 s33, s49, 0
    v_add_u32 v219, 114688, v11
    s_lshl_b32 s60, s3, 10
    v_add_u32 v217, s60, v11
    v_add_u32 v218, 0x8000, v217
    s_lshl_b32 s61, s7, 5
    s_add_u32 s60, s60, s61
    s_add_u32 s60, s60, 0x61c0
    v_and_b32_e64 v217, 7, v1
    v_lshl_add_u32 v217, v217, 2, s60
    s_lshl_b32 s56, s54, 15
    s_lshl_b32 s60, s52, 12
    s_add_u32 s56, s56, s60
    s_lshl_b32 s60, s5, 16
    s_add_u32 s60, s60, s56
    s_add_u32 s28, s60, 0xb00000
    s_add_u32 s28, s48, s28
    s_addc_u32 s29, s49, 0
    s_waitcnt lgkmcnt(2)
    v_cmp_eq_u32 vcc, 127, v59
    s_nop 1
    v_cndmask_b32 v112, v112, v12, vcc
    v_cvt_pk_bf16_f32 v120, v96, v97
    v_cvt_pk_bf16_f32 v121, v98, v99
    v_cvt_pk_bf16_f32 v122, v100, v101
    v_cvt_pk_bf16_f32 v123, v102, v103
    v_cvt_pk_bf16_f32 v124, v104, v105
    v_cvt_pk_bf16_f32 v125, v106, v107
    v_cvt_pk_bf16_f32 v126, v108, v109
    v_cvt_pk_bf16_f32 v127, v110, v111
    v_cvt_pk_bf16_f32 v128, v97, v98
    v_cvt_pk_bf16_f32 v129, v99, v100
    v_cvt_pk_bf16_f32 v130, v101, v102
    v_cvt_pk_bf16_f32 v131, v103, v104
    v_cvt_pk_bf16_f32 v132, v105, v106
    v_cvt_pk_bf16_f32 v133, v107, v108
    v_cvt_pk_bf16_f32 v134, v109, v110
    v_cvt_pk_bf16_f32 v135, v111, v112
    ds_write_b128 v2, v[120:123]
    ds_write_b128 v2, v[124:127] offset:16
    ds_write_b128 v2, v[128:131] offset:4160
    ds_write_b128 v2, v[132:135] offset:4176
    v_lshlrev_b32 v2, 4, v1
    s_mov_b32 s80, 0
    s_waitcnt vmcnt(0)
L_xv_p:
    v_xor_b32 v28, s81, v242
    v_xor_b32 v29, s81, v246
    v_or_b32 v28, v28, v29
    v_xor_b32 v29, s81, v250
    v_or_b32 v28, v28, v29
    v_xor_b32 v29, s81, v254
    v_or_b32 v28, v28, v29
    v_xor_b32 v29, s81, v23
    v_or_b32 v28, v28, v29
    v_xor_b32 v29, s81, v83
    v_or_b32 v28, v28, v29
    v_xor_b32 v29, s81, v87
    v_or_b32 v28, v28, v29
    v_xor_b32 v29, s81, v91
    v_or_b32 v28, v28, v29
    v_xor_b32_e64 v29, s81, v95
    v_or_b32 v28, v28, v29
    v_cmp_ne_u32 vcc, 0, v28
    s_nop 0
    s_cbranch_vccz L_xv_w
    s_add_u32 s80, s80, 1
    s_cmp_gt_u32 s80, 0x80000
    s_cbranch_scc1 L_xv_w
    global_load_dwordx4 v[240:243], v16, s[62:63] sc1
    global_load_dwordx4 v[244:247], v17, s[62:63] sc1
    global_load_dwordx4 v[248:251], v18, s[62:63] sc1
    global_load_dwordx4 v[252:255], v19, s[62:63] sc1
    global_load_dwordx2 v[22:23], v21, s[64:65] sc1
    global_load_dwordx4 v[80:83], v24, s[24:25] offset:0 sc1
    global_load_dwordx4 v[84:87], v24, s[24:25] offset:1024 sc1
    global_load_dwordx4 v[88:91], v24, s[24:25] offset:2048 sc1
    global_load_dwordx4 v[92:95], v24, s[24:25] offset:3072 sc1
    s_waitcnt vmcnt(0)
    s_branch L_xv_p
L_xv_w:
    v_add_f32_dpp v22, v22, v22 quad_perm:[1,0,3,2] row_mask:0xf bank_mask:0xf
    s_lshl_b32 s60, s52, 2
    s_add_u32 s61, s60, 24
    v_add_f32_dpp v22, v22, v22 quad_perm:[2,3,0,1] row_mask:0xf bank_mask:0xf
    s_add_u32 s60, s60, 16
    v_cmp_eq_u32 vcc, 1, v9
    v_add_f32_dpp v22, v22, v22 row_half_mirror row_mask:0xc bank_mask:0xf
    v_cvt_pk_bf16_f32 v22, v22, v22
    v_and_b32 v22, s58, v22
    v_add_f32 v22, v22, v4
    v_cvt_pk_bf16_f32 v22, v22, v22
    v_and_b32 v22, s58, v22
    s_nop 0
    v_readlane_b32 s62, v22, 0
    v_readlane_b32 s63, v22, 4
    v_readlane_b32 s64, v22, 8
    v_readlane_b32 s65, v22, 12
    v_readlane_b32 s75, v22, s60
    v_readlane_b32 s76, v22, s61
    v_mov_b32 v27, s62
    v_mov_b32 v29, s63
    v_mov_b32 v26, s64
    v_mov_b32 v28, s65
    v_cndmask_b32 v27, v27, v29, vcc
    v_cndmask_b32 v26, v26, v28, vcc
    ds_write_b64 v25, v[240:241] offset:42240
    v_mov_b32_dpp v56, v80 quad_perm:[0,1,0,1] row_mask:0xf bank_mask:0xf
    v_mov_b32_dpp v57, v81 quad_perm:[0,1,0,1] row_mask:0xf bank_mask:0xf
    v_mov_b32_dpp v58, v82 quad_perm:[0,1,0,1] row_mask:0xf bank_mask:0xf
    v_lshlrev_b32 v48, 16, v240
    v_and_b32 v49, s58, v240
    v_lshlrev_b32 v50, 16, v58
    v_and_b32 v51, s58, v58
    v_pk_fma_f32 v[48:49], v[48:49], v[56:57], v[50:51] neg_lo:[0,0,1] neg_hi:[0,0,1]
    v_pk_fma_f32 v[48:49], v[48:49], v[26:27], v[26:27] op_sel:[0,0,1] op_sel_hi:[1,0,1]
    v_cvt_pk_bf16_f32 v242, v48, v49
    v_mov_b32_dpp v60, v80 quad_perm:[2,3,2,3] row_mask:0xf bank_mask:0xf
    v_mov_b32_dpp v61, v81 quad_perm:[2,3,2,3] row_mask:0xf bank_mask:0xf
    v_mov_b32_dpp v62, v82 quad_perm:[2,3,2,3] row_mask:0xf bank_mask:0xf
    v_lshlrev_b32 v52, 16, v241
    v_and_b32 v53, s58, v241
    v_lshlrev_b32 v54, 16, v62
    v_and_b32 v55, s58, v62
    v_pk_fma_f32 v[52:53], v[52:53], v[60:61], v[54:55] neg_lo:[0,0,1] neg_hi:[0,0,1]
    v_pk_fma_f32 v[52:53], v[52:53], v[26:27], v[26:27] op_sel:[0,0,1] op_sel_hi:[1,0,1]
    v_cvt_pk_bf16_f32 v243, v52, v53
    ds_write_b64 v20, v[242:243] offset:8832
    ds_write_b64 v25, v[244:245] offset:42496
    v_mov_b32_dpp v56, v84 quad_perm:[0,1,0,1] row_mask:0xf bank_mask:0xf
    v_mov_b32_dpp v57, v85 quad_perm:[0,1,0,1] row_mask:0xf bank_mask:0xf
    v_mov_b32_dpp v58, v86 quad_perm:[0,1,0,1] row_mask:0xf bank_mask:0xf
    v_lshlrev_b32 v48, 16, v244
    v_and_b32 v49, s58, v244
    v_lshlrev_b32 v50, 16, v58
    v_and_b32 v51, s58, v58
    v_pk_fma_f32 v[48:49], v[48:49], v[56:57], v[50:51] neg_lo:[0,0,1] neg_hi:[0,0,1]
    v_pk_fma_f32 v[48:49], v[48:49], v[26:27], v[26:27] op_sel:[0,0,1] op_sel_hi:[1,0,1]
    v_cvt_pk_bf16_f32 v246, v48, v49
    v_mov_b32_dpp v60, v84 quad_perm:[2,3,2,3] row_mask:0xf bank_mask:0xf
    v_mov_b32_dpp v61, v85 quad_perm:[2,3,2,3] row_mask:0xf bank_mask:0xf
    v_mov_b32_dpp v62, v86 quad_perm:[2,3,2,3] row_mask:0xf bank_mask:0xf
    v_lshlrev_b32 v52, 16, v245
    v_and_b32 v53, s58, v245
    v_lshlrev_b32 v54, 16, v62
    v_and_b32 v55, s58, v62
    v_pk_fma_f32 v[52:53], v[52:53], v[60:61], v[54:55] neg_lo:[0,0,1] neg_hi:[0,0,1]
    v_pk_fma_f32 v[52:53], v[52:53], v[26:27], v[26:27] op_sel:[0,0,1] op_sel_hi:[1,0,1]
    v_cvt_pk_bf16_f32 v247, v52, v53
    ds_write_b64 v20, v[246:247] offset:9088
    ds_write_b64 v25, v[248:249] offset:42752
    v_mov_b32_dpp v56, v88 quad_perm:[0,1,0,1] row_mask:0xf bank_mask:0xf
    v_mov_b32_dpp v57, v89 quad_perm:[0,1,0,1] row_mask:0xf bank_mask:0xf
    v_mov_b32_dpp v58, v90 quad_perm:[0,1,0,1] row_mask:0xf bank_mask:0xf
    v_lshlrev_b32 v48, 16, v248
    v_and_b32 v49, s58, v248
    v_lshlrev_b32 v50, 16, v58
    v_and_b32 v51, s58, v58
    v_pk_fma_f32 v[48:49], v[48:49], v[56:57], v[50:51] neg_lo:[0,0,1] neg_hi:[0,0,1]
    v_pk_fma_f32 v[48:49], v[48:49], v[26:27], v[26:27] op_sel:[0,0,1] op_sel_hi:[1,0,1]
    v_cvt_pk_bf16_f32 v250, v48, v49
    v_mov_b32_dpp v60, v88 quad_perm:[2,3,2,3] row_mask:0xf bank_mask:0xf
    v_mov_b32_dpp v61, v89 quad_perm:[2,3,2,3] row_mask:0xf bank_mask:0xf
    v_mov_b32_dpp v62, v90 quad_perm:[2,3,2,3] row_mask:0xf bank_mask:0xf
    v_lshlrev_b32 v52, 16, v249
    v_and_b32 v53, s58, v249
    v_lshlrev_b32 v54, 16, v62
    v_and_b32 v55, s58, v62
    v_pk_fma_f32 v[52:53], v[52:53], v[60:61], v[54:55] neg_lo:[0,0,1] neg_hi:[0,0,1]
    v_pk_fma_f32 v[52:53], v[52:53], v[26:27], v[26:27] op_sel:[0,0,1] op_sel_hi:[1,0,1]
    v_cvt_pk_bf16_f32 v251, v52, v53
    ds_write_b64 v20, v[250:251] offset:9344
    ds_write_b64 v25, v[252:253] offset:43008
    v_mov_b32_dpp v56, v92 quad_perm:[0,1,0,1] row_mask:0xf bank_mask:0xf
    v_mov_b32_dpp v57, v93 quad_perm:[0,1,0,1] row_mask:0xf bank_mask:0xf
    v_mov_b32_dpp v58, v94 quad_perm:[0,1,0,1] row_mask:0xf bank_mask:0xf
    v_lshlrev_b32 v48, 16, v252
    v_and_b32 v49, s58, v252
    v_lshlrev_b32 v50, 16, v58
    v_and_b32 v51, s58, v58
    v_pk_fma_f32 v[48:49], v[48:49], v[56:57], v[50:51] neg_lo:[0,0,1] neg_hi:[0,0,1]
    v_pk_fma_f32 v[48:49], v[48:49], v[26:27], v[26:27] op_sel:[0,0,1] op_sel_hi:[1,0,1]
    v_cvt_pk_bf16_f32 v254, v48, v49
    v_mov_b32_dpp v60, v92 quad_perm:[2,3,2,3] row_mask:0xf bank_mask:0xf
    v_mov_b32_dpp v61, v93 quad_perm:[2,3,2,3] row_mask:0xf bank_mask:0xf
    v_mov_b32_dpp v62, v94 quad_perm:[2,3,2,3] row_mask:0xf bank_mask:0xf
    v_lshlrev_b32 v52, 16, v253
    v_and_b32 v53, s58, v253
    v_lshlrev_b32 v54, 16, v62
    v_and_b32 v55, s58, v62
    v_pk_fma_f32 v[52:53], v[52:53], v[60:61], v[54:55] neg_lo:[0,0,1] neg_hi:[0,0,1]
    v_pk_fma_f32 v[52:53], v[52:53], v[26:27], v[26:27] op_sel:[0,0,1] op_sel_hi:[1,0,1]
    v_cvt_pk_bf16_f32 v255, v52, v53
    ds_write_b64 v20, v[254:255] offset:9600
    s_waitcnt lgkmcnt(0)
    s_barrier
    ds_read2_b32 v[64:65], v194 offset0:176 offset1:177
    ds_read2_b32 v[66:67], v194 offset0:178 offset1:179
    ds_read_b128 v[96:99], v192 offset:192
    ds_read2_b32 v[68:69], v194 offset0:48 offset1:49
    ds_read2_b32 v[70:71], v194 offset0:50 offset1:51
    ds_read_b128 v[100:103], v192 offset:704
    ds_read2_b32 v[72:73], v195 offset0:176 offset1:177
    ds_read2_b32 v[74:75], v195 offset0:178 offset1:179
    ds_read_b128 v[104:107], v192 offset:1216
    ds_read2_b32 v[76:77], v195 offset0:48 offset1:49
    ds_read2_b32 v[78:79], v195 offset0:50 offset1:51
    ds_read_b128 v[108:111], v192 offset:1728
    ds_read2_b32 v[80:81], v194 offset0:160 offset1:161
    ds_read2_b32 v[82:83], v194 offset0:162 offset1:163
    ds_read_b128 v[112:115], v192 offset:128
    ds_read2_b32 v[84:85], v194 offset0:32 offset1:33
    ds_read2_b32 v[86:87], v194 offset0:34 offset1:35
    ds_read_b128 v[116:119], v192 offset:640
    ds_read2_b32 v[88:89], v195 offset0:160 offset1:161
    ds_read2_b32 v[90:91], v195 offset0:162 offset1:163
    ds_read_b128 v[120:123], v192 offset:1152
    ds_read2_b32 v[92:93], v195 offset0:32 offset1:33
    ds_read2_b32 v[94:95], v195 offset0:34 offset1:35
    ds_read_b128 v[124:127], v192 offset:1664
    s_cmp_lg_u32 s50, 3
    s_cbranch_scc1 L_fin
    v_readlane_b32 s60, v22, 32
    v_readlane_b32 s61, v22, 40
    s_lshr_b32 s60, s60, 16
    s_or_b32 s60, s60, s61
    v_mov_b32_e64 v220, s60
    v_readlane_b32 s60, v22, 24
    v_readlane_b32 s61, v22, 28
    s_lshr_b32 s60, s60, 16
    s_or_b32 s60, s60, s61
    v_mov_b32_e64 v221, s60
    v_readlane_b32 s60, v22, 48
    v_readlane_b32 s61, v22, 56
    s_lshr_b32 s60, s60, 16
    s_or_b32 s60, s60, s61
    v_mov_b32_e64 v222, s60
    v_mov_b32 v223, s81
    s_mov_b64 exec, 1
    global_store_dwordx4 v12, v[220:223], s[18:19] sc1
    s_mov_b64 exec, -1
L_fin:
    s_waitcnt lgkmcnt(15)
    v_mfma_f32_16x16x32_bf16 v[32:35], v[64:67], v[96:99], 0
    v_mfma_f32_16x16x32_bf16 v[36:39], v[64:67], v[100:103], 0
    v_mfma_f32_16x16x32_bf16 v[36:39], v[68:71], v[96:99], v[36:39]
    ds_read2_b32 v[128:129], v194 offset0:144 offset1:145
    ds_read2_b32 v[130:131], v194 offset0:146 offset1:147
    v_mfma_f32_16x16x32_bf16 v[40:43], v[68:71], v[100:103], 0
    ds_read_b128 v[160:163], v192 offset:64
    ds_read2_b32 v[132:133], v194 offset0:16 offset1:17
    v_mfma_f32_16x16x32_bf16 v[40:43], v[64:67], v[104:107], v[40:43]
    ds_read2_b32 v[134:135], v194 offset0:18 offset1:19
    ds_read_b128 v[164:167], v192 offset:576
    v_mfma_f32_16x16x32_bf16 v[44:47], v[68:71], v[104:107], 0
    ds_read2_b32 v[136:137], v195 offset0:144 offset1:145
    ds_read2_b32 v[138:139], v195 offset0:146 offset1:147
    v_mfma_f32_16x16x32_bf16 v[40:43], v[72:75], v[96:99], v[40:43]
    ds_read_b128 v[168:171], v192 offset:1088
    ds_read2_b32 v[140:141], v195 offset0:16 offset1:17
    v_mfma_f32_16x16x32_bf16 v[44:47], v[72:75], v[100:103], v[44:47]
    ds_read2_b32 v[142:143], v195 offset0:18 offset1:19
    ds_read_b128 v[172:175], v192 offset:1600
    s_nop 0
    s_waitcnt lgkmcnt(15)
    v_mfma_f32_16x16x32_bf16 v[44:47], v[64:67], v[108:111], v[44:47]
    ds_read2_b32 v[144:145], v194 offset0:128 offset1:129
    ds_read2_b32 v[146:147], v194 offset0:130 offset1:131
    v_mfma_f32_16x16x32_bf16 v[44:47], v[76:79], v[96:99], v[44:47]
    ds_read_b128 v[176:179], v192 offset:0
    ds_read2_b32 v[148:149], v194 offset0:0 offset1:1
    v_mfma_f32_16x16x32_bf16 v[32:35], v[80:83], v[112:115], v[32:35]
    ds_read2_b32 v[150:151], v194 offset0:2 offset1:3
    ds_read_b128 v[180:183], v192 offset:512
    v_mfma_f32_16x16x32_bf16 v[36:39], v[80:83], v[116:119], v[36:39]
    ds_read2_b32 v[152:153], v195 offset0:128 offset1:129
    ds_read2_b32 v[154:155], v195 offset0:130 offset1:131
    v_mfma_f32_16x16x32_bf16 v[36:39], v[84:87], v[112:115], v[36:39]
    ds_read_b128 v[184:187], v192 offset:1024
    ds_read2_b32 v[156:157], v195 offset0:0 offset1:1
    v_mfma_f32_16x16x32_bf16 v[40:43], v[84:87], v[116:119], v[40:43]
    ds_read2_b32 v[158:159], v195 offset0:2 offset1:3
    ds_read_b128 v[188:191], v192 offset:1536
    v_mfma_f32_16x16x32_bf16 v[40:43], v[80:83], v[120:123], v[40:43]
    ds_read_b64 v[16:17], v193 offset:8832
    ds_read_b64 v[18:19], v193 offset:9344
    v_mfma_f32_16x16x32_bf16 v[44:47], v[84:87], v[120:123], v[44:47]
    ds_read_b64 v[20:21], v202 offset:42240
    ds_read_b64 v[22:23], v202 offset:42752
    v_mfma_f32_16x16x32_bf16 v[40:43], v[88:91], v[112:115], v[40:43]
    v_mfma_f32_16x16x32_bf16 v[44:47], v[88:91], v[116:119], v[44:47]
    s_nop 0
    s_waitcnt lgkmcnt(15)
    v_mfma_f32_16x16x32_bf16 v[44:47], v[80:83], v[124:127], v[44:47]
    v_mfma_f32_16x16x32_bf16 v[44:47], v[92:95], v[112:115], v[44:47]
    v_mfma_f32_16x16x32_bf16 v[32:35], v[128:131], v[160:163], v[32:35]
    v_mfma_f32_16x16x32_bf16 v[36:39], v[128:131], v[164:167], v[36:39]
    v_mfma_f32_16x16x32_bf16 v[36:39], v[132:135], v[160:163], v[36:39]
    ds_read2_b32 v[64:65], v194 offset0:176 offset1:177
    ds_read2_b32 v[66:67], v194 offset0:178 offset1:179
    v_mfma_f32_16x16x32_bf16 v[40:43], v[132:135], v[164:167], v[40:43]
    ds_read_b128 v[96:99], v192 offset:192
    ds_read2_b32 v[68:69], v194 offset0:48 offset1:49
    v_mfma_f32_16x16x32_bf16 v[40:43], v[128:131], v[168:171], v[40:43]
    ds_read2_b32 v[70:71], v194 offset0:50 offset1:51
    ds_read_b128 v[100:103], v192 offset:704
    v_mfma_f32_16x16x32_bf16 v[44:47], v[132:135], v[168:171], v[44:47]
    ds_read2_b32 v[72:73], v195 offset0:176 offset1:177
    ds_read2_b32 v[74:75], v195 offset0:178 offset1:179
    v_mfma_f32_16x16x32_bf16 v[40:43], v[136:139], v[160:163], v[40:43]
    ds_read_b128 v[104:107], v192 offset:1216
    ds_read2_b32 v[76:77], v195 offset0:48 offset1:49
    v_mfma_f32_16x16x32_bf16 v[44:47], v[136:139], v[164:167], v[44:47]
    ds_read2_b32 v[78:79], v195 offset0:50 offset1:51
    ds_read_b128 v[108:111], v192 offset:1728
    v_mfma_f32_16x16x32_bf16 v[44:47], v[128:131], v[172:175], v[44:47]
    ds_read2_b32 v[80:81], v196 offset0:176 offset1:177
    ds_read2_b32 v[82:83], v196 offset0:178 offset1:179
    v_mfma_f32_16x16x32_bf16 v[44:47], v[140:143], v[160:163], v[44:47]
    ds_read_b128 v[112:115], v192 offset:2240
    ds_read2_b32 v[84:85], v196 offset0:48 offset1:49
    s_nop 0
    s_waitcnt lgkmcnt(15)
    v_mfma_f32_16x16x32_bf16 v[32:35], v[144:147], v[176:179], v[32:35]
    ds_read2_b32 v[86:87], v196 offset0:50 offset1:51
    ds_read_b128 v[116:119], v192 offset:2752
    v_mfma_f32_16x16x32_bf16 v[36:39], v[144:147], v[180:183], v[36:39]
    ds_read2_b32 v[88:89], v197 offset0:176 offset1:177
    ds_read2_b32 v[90:91], v197 offset0:178 offset1:179
    v_mfma_f32_16x16x32_bf16 v[36:39], v[148:151], v[176:179], v[36:39]
    ds_read_b128 v[120:123], v192 offset:3264
    ds_read2_b32 v[92:93], v197 offset0:48 offset1:49
    v_mfma_f32_16x16x32_bf16 v[40:43], v[148:151], v[180:183], v[40:43]
    ds_read2_b32 v[94:95], v197 offset0:50 offset1:51
    ds_read_b128 v[124:127], v192 offset:3776
    v_mfma_f32_16x16x32_bf16 v[40:43], v[144:147], v[184:187], v[40:43]
    v_mfma_f32_16x16x32_bf16 v[44:47], v[148:151], v[184:187], v[44:47]
    v_mfma_f32_16x16x32_bf16 v[40:43], v[152:155], v[176:179], v[40:43]
    v_mfma_f32_16x16x32_bf16 v[44:47], v[152:155], v[180:183], v[44:47]
    v_mfma_f32_16x16x32_bf16 v[44:47], v[144:147], v[188:191], v[44:47]
    v_mfma_f32_16x16x32_bf16 v[44:47], v[156:159], v[176:179], v[44:47]
    s_nop 7
    s_cmp_eq_u32 s54, 0
    s_cbranch_scc0 L_cvA_1
    ds_write_b128 v198, v[40:43] offset:12928
    ds_write_b128 v198, v[44:47] offset:13952
    v_mov_b64 v[224:225], v[32:33]
    v_mov_b64 v[226:227], v[34:35]
    v_mov_b64 v[228:229], v[36:37]
    v_mov_b64 v[230:231], v[38:39]
    s_branch L_cvA_2
L_cvA_1:
    ds_write_b128 v198, v[32:35] offset:12928
    ds_write_b128 v198, v[36:39] offset:13952
    v_mov_b64 v[224:225], v[40:41]
    v_mov_b64 v[226:227], v[42:43]
    v_mov_b64 v[228:229], v[44:45]
    v_mov_b64 v[230:231], v[46:47]
L_cvA_2:
    s_waitcnt lgkmcnt(0)
    s_barrier
    ds_read_b128 v[232:235], v199 offset:12928
    ds_read_b128 v[236:239], v199 offset:13952
    v_lshlrev_b32 v240, 16, v16
    v_and_b32 v241, s58, v16
    v_pk_fma_f32 v[224:225], v[240:241], s[74:75], v[224:225] op_sel_hi:[1,0,1]
    v_lshlrev_b32 v248, 16, v20
    v_and_b32 v249, s58, v20
    v_lshlrev_b32 v242, 16, v17
    v_and_b32 v243, s58, v17
    v_pk_fma_f32 v[226:227], v[242:243], s[74:75], v[226:227] op_sel_hi:[1,0,1]
    v_lshlrev_b32 v250, 16, v21
    v_and_b32 v251, s58, v21
    v_lshlrev_b32 v244, 16, v18
    v_and_b32 v245, s58, v18
    v_pk_fma_f32 v[228:229], v[244:245], s[74:75], v[228:229] op_sel_hi:[1,0,1]
    v_lshlrev_b32 v252, 16, v22
    v_and_b32 v253, s58, v22
    v_lshlrev_b32 v246, 16, v19
    v_and_b32 v247, s58, v19
    v_pk_fma_f32 v[230:231], v[246:247], s[74:75], v[230:231] op_sel_hi:[1,0,1]
    v_lshlrev_b32_e64 v254, 16, v23
    v_and_b32 v255, s58, v23
    s_waitcnt lgkmcnt(0)
    v_pk_add_f32 v[224:225], v[224:225], v[232:233]
    v_pk_fma_f32 v[224:225], v[224:225], s[74:75], v[248:249] op_sel:[0,1,0] op_sel_hi:[1,1,1]
    v_pk_mul_f32 v[240:241], v[224:225], s[76:77] op_sel_hi:[1,0]
    v_cvt_pk_bf16_f32 v24, v240, v241
    v_cvt_pk_bf16_f32 v28, v224, v225
    v_pk_add_f32 v[226:227], v[226:227], v[234:235]
    v_pk_fma_f32 v[226:227], v[226:227], s[74:75], v[250:251] op_sel:[0,1,0] op_sel_hi:[1,1,1]
    v_pk_mul_f32 v[242:243], v[226:227], s[76:77] op_sel_hi:[1,0]
    v_cvt_pk_bf16_f32 v25, v242, v243
    v_cvt_pk_bf16_f32 v29, v226, v227
    v_pk_add_f32 v[228:229], v[228:229], v[236:237]
    v_pk_fma_f32 v[228:229], v[228:229], s[74:75], v[252:253] op_sel:[0,1,0] op_sel_hi:[1,1,1]
    v_pk_mul_f32 v[244:245], v[228:229], s[76:77] op_sel_hi:[1,0]
    v_cvt_pk_bf16_f32 v26, v244, v245
    v_cvt_pk_bf16_f32 v30, v228, v229
    v_pk_add_f32 v[230:231], v[230:231], v[238:239]
    v_pk_fma_f32 v[230:231], v[230:231], s[74:75], v[254:255] op_sel:[0,1,0] op_sel_hi:[1,1,1]
    v_pk_mul_f32 v[246:247], v[230:231], s[76:77] op_sel_hi:[1,0]
    v_cvt_pk_bf16_f32 v27, v246, v247
    v_cvt_pk_bf16_f32 v31, v230, v231
    v_permlane16_swap_b32 v24, v26
    v_permlane16_swap_b32 v25, v27
    global_store_dwordx4 v200, v[24:27], s[68:69] sc1
    v_permlane16_swap_b32 v28, v30
    v_permlane16_swap_b32 v29, v31
    global_store_dwordx4 v200, v[28:31], s[66:67] sc1
    v_mfma_f32_16x16x32_bf16 v[48:51], v[72:75], v[104:107], 0
    v_mfma_f32_16x16x32_bf16 v[48:51], v[68:71], v[108:111], v[48:51]
    ds_read2_b32 v[128:129], v194 offset0:160 offset1:161
    v_mfma_f32_16x16x32_bf16 v[52:55], v[72:75], v[108:111], 0
    ds_read2_b32 v[130:131], v194 offset0:162 offset1:163
    v_mfma_f32_16x16x32_bf16 v[48:51], v[76:79], v[100:103], v[48:51]
    ds_read_b128 v[160:163], v192 offset:128
    v_mfma_f32_16x16x32_bf16 v[52:55], v[76:79], v[104:107], v[52:55]
    ds_read2_b32 v[132:133], v194 offset0:32 offset1:33
    v_mfma_f32_16x16x32_bf16 v[56:59], v[76:79], v[108:111], 0
    ds_read2_b32 v[134:135], v194 offset0:34 offset1:35
    v_mfma_f32_16x16x32_bf16 v[48:51], v[64:67], v[112:115], v[48:51]
    ds_read_b128 v[164:167], v192 offset:640
    v_mfma_f32_16x16x32_bf16 v[52:55], v[68:71], v[112:115], v[52:55]
    ds_read2_b32 v[136:137], v195 offset0:160 offset1:161
    v_mfma_f32_16x16x32_bf16 v[56:59], v[72:75], v[112:115], v[56:59]
    ds_read2_b32 v[138:139], v195 offset0:162 offset1:163
    v_mfma_f32_16x16x32_bf16 v[60:63], v[76:79], v[112:115], 0
    ds_read_b128 v[168:171], v192 offset:1152
    s_cmp_lg_u32 s50, 1
    s_cbranch_scc1 L_fp_i
    global_load_dword v204, v217, s[14:15] sc1
L_fp_i:
    v_mfma_f32_16x16x32_bf16 v[48:51], v[80:83], v[96:99], v[48:51]
    ds_read2_b32 v[140:141], v195 offset0:32 offset1:33
    v_mfma_f32_16x16x32_bf16 v[52:55], v[80:83], v[100:103], v[52:55]
    ds_read2_b32 v[142:143], v195 offset0:34 offset1:35
    v_mfma_f32_16x16x32_bf16 v[56:59], v[80:83], v[104:107], v[56:59]
    ds_read_b128 v[172:175], v192 offset:1664
    v_mfma_f32_16x16x32_bf16 v[60:63], v[80:83], v[108:111], v[60:63]
    ds_read2_b32 v[144:145], v196 offset0:160 offset1:161
    v_mfma_f32_16x16x32_bf16 v[52:55], v[64:67], v[116:119], v[52:55]
    ds_read2_b32 v[146:147], v196 offset0:162 offset1:163
    v_mfma_f32_16x16x32_bf16 v[56:59], v[68:71], v[116:119], v[56:59]
    ds_read_b128 v[176:179], v192 offset:2176
    v_mfma_f32_16x16x32_bf16 v[60:63], v[72:75], v[116:119], v[60:63]
    ds_read2_b32 v[148:149], v196 offset0:32 offset1:33
    v_mfma_f32_16x16x32_bf16 v[52:55], v[84:87], v[96:99], v[52:55]
    ds_read2_b32 v[150:151], v196 offset0:34 offset1:35
    v_mfma_f32_16x16x32_bf16 v[56:59], v[84:87], v[100:103], v[56:59]
    ds_read_b128 v[180:183], v192 offset:2688
    v_mfma_f32_16x16x32_bf16 v[60:63], v[84:87], v[104:107], v[60:63]
    ds_read2_b32 v[152:153], v197 offset0:160 offset1:161
    v_mfma_f32_16x16x32_bf16 v[56:59], v[64:67], v[120:123], v[56:59]
    ds_read2_b32 v[154:155], v197 offset0:162 offset1:163
    v_mfma_f32_16x16x32_bf16 v[60:63], v[68:71], v[120:123], v[60:63]
    ds_read_b128 v[184:187], v192 offset:3200
    v_mfma_f32_16x16x32_bf16 v[56:59], v[88:91], v[96:99], v[56:59]
    ds_read2_b32 v[156:157], v197 offset0:32 offset1:33
    v_mfma_f32_16x16x32_bf16 v[60:63], v[88:91], v[100:103], v[60:63]
    ds_read2_b32 v[158:159], v197 offset0:34 offset1:35
    v_mfma_f32_16x16x32_bf16 v[60:63], v[64:67], v[124:127], v[60:63]
    ds_read_b128 v[188:191], v192 offset:3712
    v_mfma_f32_16x16x32_bf16 v[60:63], v[92:95], v[96:99], v[60:63]
    s_nop 0
    s_waitcnt lgkmcnt(0)
    v_mfma_f32_16x16x32_bf16 v[48:51], v[136:139], v[168:171], v[48:51]
    v_mfma_f32_16x16x32_bf16 v[48:51], v[132:135], v[172:175], v[48:51]
    ds_read2_b32 v[64:65], v194 offset0:144 offset1:145
    v_mfma_f32_16x16x32_bf16 v[52:55], v[136:139], v[172:175], v[52:55]
    ds_read2_b32 v[66:67], v194 offset0:146 offset1:147
    v_mfma_f32_16x16x32_bf16 v[48:51], v[140:143], v[164:167], v[48:51]
    ds_read_b128 v[96:99], v192 offset:64
    v_mfma_f32_16x16x32_bf16 v[52:55], v[140:143], v[168:171], v[52:55]
    ds_read2_b32 v[68:69], v194 offset0:16 offset1:17
    v_mfma_f32_16x16x32_bf16 v[56:59], v[140:143], v[172:175], v[56:59]
    ds_read2_b32 v[70:71], v194 offset0:18 offset1:19
    v_mfma_f32_16x16x32_bf16 v[48:51], v[128:131], v[176:179], v[48:51]
    ds_read_b128 v[100:103], v192 offset:576
    v_mfma_f32_16x16x32_bf16 v[52:55], v[132:135], v[176:179], v[52:55]
    ds_read2_b32 v[72:73], v195 offset0:144 offset1:145
    v_mfma_f32_16x16x32_bf16 v[56:59], v[136:139], v[176:179], v[56:59]
    ds_read2_b32 v[74:75], v195 offset0:146 offset1:147
    v_mfma_f32_16x16x32_bf16 v[60:63], v[140:143], v[176:179], v[60:63]
    ds_read_b128 v[104:107], v192 offset:1088
    v_mfma_f32_16x16x32_bf16 v[48:51], v[144:147], v[160:163], v[48:51]
    ds_read2_b32 v[76:77], v195 offset0:16 offset1:17
    v_mfma_f32_16x16x32_bf16 v[52:55], v[144:147], v[164:167], v[52:55]
    ds_read2_b32 v[78:79], v195 offset0:18 offset1:19
    v_mfma_f32_16x16x32_bf16 v[56:59], v[144:147], v[168:171], v[56:59]
    ds_read_b128 v[108:111], v192 offset:1600
    v_mfma_f32_16x16x32_bf16 v[60:63], v[144:147], v[172:175], v[60:63]
    ds_read2_b32 v[80:81], v196 offset0:144 offset1:145
    v_mfma_f32_16x16x32_bf16 v[52:55], v[128:131], v[180:183], v[52:55]
    ds_read2_b32 v[82:83], v196 offset0:146 offset1:147
    v_mfma_f32_16x16x32_bf16 v[56:59], v[132:135], v[180:183], v[56:59]
    ds_read_b128 v[112:115], v192 offset:2112
    v_mfma_f32_16x16x32_bf16 v[60:63], v[136:139], v[180:183], v[60:63]
    ds_read2_b32 v[84:85], v196 offset0:16 offset1:17
    v_mfma_f32_16x16x32_bf16 v[52:55], v[148:151], v[160:163], v[52:55]
    ds_read2_b32 v[86:87], v196 offset0:18 offset1:19
    v_mfma_f32_16x16x32_bf16 v[56:59], v[148:151], v[164:167], v[56:59]
    ds_read_b128 v[116:119], v192 offset:2624
    v_mfma_f32_16x16x32_bf16 v[60:63], v[148:151], v[168:171], v[60:63]
    ds_read2_b32 v[88:89], v197 offset0:144 offset1:145
    v_mfma_f32_16x16x32_bf16 v[56:59], v[128:131], v[184:187], v[56:59]
    ds_read2_b32 v[90:91], v197 offset0:146 offset1:147
    v_mfma_f32_16x16x32_bf16 v[60:63], v[132:135], v[184:187], v[60:63]
    ds_read_b128 v[120:123], v192 offset:3136
    v_mfma_f32_16x16x32_bf16 v[56:59], v[152:155], v[160:163], v[56:59]
    ds_read2_b32 v[92:93], v197 offset0:16 offset1:17
    v_mfma_f32_16x16x32_bf16 v[60:63], v[152:155], v[164:167], v[60:63]
    ds_read2_b32 v[94:95], v197 offset0:18 offset1:19
    v_mfma_f32_16x16x32_bf16 v[60:63], v[128:131], v[188:191], v[60:63]
    ds_read_b128 v[124:127], v192 offset:3648
    v_mfma_f32_16x16x32_bf16 v[60:63], v[156:159], v[160:163], v[60:63]
    s_waitcnt lgkmcnt(0)
    s_cmp_lg_u32 s50, 1
    s_cbranch_scc1 L_fp_w
    s_mov_b32 s80, 0
    s_waitcnt vmcnt(0)
L_fp_p:
    v_xor_b32_e64 v210, s81, v204
    v_cmp_ne_u32 vcc, 0, v210
    s_nop 0
    s_cbranch_vccz L_fp_w
    s_add_u32 s80, s80, 1
    s_cmp_gt_u32 s80, 0x80000
    s_cbranch_scc1 L_fp_w
    s_sleep 1
    global_load_dword v204, v217, s[14:15] sc1
    s_waitcnt vmcnt(0)
    s_branch L_fp_p
L_fp_w:
    s_waitcnt vmcnt(0)
    s_barrier
    s_cmp_lg_u32 s50, 1
    s_cbranch_scc1 L_f2a_s
    s_lshl_b32 s80, s2, 2
    s_add_u32 s80, s80, 0x8000
    v_lshl_add_u32 v208, v1, 10, s80
    v_mov_b32 v209, s81
    s_mov_b64 exec, 255
    global_store_dword v208, v209, s[14:15] sc1
    s_mov_b64 exec, -1
L_f2a_s:
    v_mfma_f32_16x16x32_bf16 v[48:51], v[72:75], v[104:107], v[48:51]
    global_load_dwordx4 a[0:3], v2, s[26:27] offset:0 sc1
    v_mfma_f32_16x16x32_bf16 v[48:51], v[68:71], v[108:111], v[48:51]
    ds_read2_b32 v[128:129], v194 offset0:128 offset1:129
    v_mfma_f32_16x16x32_bf16 v[52:55], v[72:75], v[108:111], v[52:55]
    ds_read2_b32 v[130:131], v194 offset0:130 offset1:131
    v_mfma_f32_16x16x32_bf16 v[48:51], v[76:79], v[100:103], v[48:51]
    ds_read_b128 v[160:163], v192 offset:0
    global_load_dwordx4 a[4:7], v2, s[26:27] offset:1024 sc1
    v_mfma_f32_16x16x32_bf16 v[52:55], v[76:79], v[104:107], v[52:55]
    ds_read2_b32 v[132:133], v194 offset0:0 offset1:1
    v_mfma_f32_16x16x32_bf16 v[56:59], v[76:79], v[108:111], v[56:59]
    ds_read2_b32 v[134:135], v194 offset0:2 offset1:3
    v_mfma_f32_16x16x32_bf16 v[48:51], v[64:67], v[112:115], v[48:51]
    ds_read_b128 v[164:167], v192 offset:512
    global_load_dwordx4 a[8:11], v2, s[26:27] offset:2048 sc1
    v_mfma_f32_16x16x32_bf16 v[52:55], v[68:71], v[112:115], v[52:55]
    ds_read2_b32 v[136:137], v195 offset0:128 offset1:129
    v_mfma_f32_16x16x32_bf16 v[56:59], v[72:75], v[112:115], v[56:59]
    ds_read2_b32 v[138:139], v195 offset0:130 offset1:131
    v_mfma_f32_16x16x32_bf16 v[60:63], v[76:79], v[112:115], v[60:63]
    ds_read_b128 v[168:171], v192 offset:1024
    global_load_dwordx4 a[12:15], v2, s[26:27] offset:3072 sc1
    s_add_u32 s26, s26, 4096
    s_nop 0
    s_addc_u32 s27, s27, 0
    v_mfma_f32_16x16x32_bf16 v[48:51], v[80:83], v[96:99], v[48:51]
    ds_read2_b32 v[140:141], v195 offset0:0 offset1:1
    v_mfma_f32_16x16x32_bf16 v[52:55], v[80:83], v[100:103], v[52:55]
    ds_read2_b32 v[142:143], v195 offset0:2 offset1:3
    v_mfma_f32_16x16x32_bf16 v[56:59], v[80:83], v[104:107], v[56:59]
    ds_read_b128 v[172:175], v192 offset:1536
    global_load_dwordx4 a[16:19], v2, s[26:27] offset:0 sc1
    v_mfma_f32_16x16x32_bf16 v[60:63], v[80:83], v[108:111], v[60:63]
    ds_read2_b32 v[144:145], v196 offset0:128 offset1:129
    v_mfma_f32_16x16x32_bf16 v[52:55], v[64:67], v[116:119], v[52:55]
    ds_read2_b32 v[146:147], v196 offset0:130 offset1:131
    v_mfma_f32_16x16x32_bf16 v[56:59], v[68:71], v[116:119], v[56:59]
    ds_read_b128 v[176:179], v192 offset:2048
    global_load_dwordx4 a[20:23], v2, s[26:27] offset:1024 sc1
    v_mfma_f32_16x16x32_bf16 v[60:63], v[72:75], v[116:119], v[60:63]
    ds_read2_b32 v[148:149], v196 offset0:0 offset1:1
    v_mfma_f32_16x16x32_bf16 v[52:55], v[84:87], v[96:99], v[52:55]
    ds_read2_b32 v[150:151], v196 offset0:2 offset1:3
    v_mfma_f32_16x16x32_bf16 v[56:59], v[84:87], v[100:103], v[56:59]
    ds_read_b128 v[180:183], v192 offset:2560
    global_load_dwordx4 a[24:27], v2, s[26:27] offset:2048 sc1
    v_mfma_f32_16x16x32_bf16 v[60:63], v[84:87], v[104:107], v[60:63]
    ds_read2_b32 v[152:153], v197 offset0:128 offset1:129
    v_mfma_f32_16x16x32_bf16 v[56:59], v[64:67], v[120:123], v[56:59]
    ds_read2_b32 v[154:155], v197 offset0:130 offset1:131
    v_mfma_f32_16x16x32_bf16 v[60:63], v[68:71], v[120:123], v[60:63]
    ds_read_b128 v[184:187], v192 offset:3072
    global_load_dwordx4 a[28:31], v2, s[26:27] offset:3072 sc1
    s_add_u32 s26, s26, 4096
    s_nop 0
    s_addc_u32 s27, s27, 0
    v_mfma_f32_16x16x32_bf16 v[56:59], v[88:91], v[96:99], v[56:59]
    ds_read2_b32 v[156:157], v197 offset0:0 offset1:1
    v_mfma_f32_16x16x32_bf16 v[60:63], v[88:91], v[100:103], v[60:63]
    ds_read2_b32 v[158:159], v197 offset0:2 offset1:3
    v_mfma_f32_16x16x32_bf16 v[60:63], v[64:67], v[124:127], v[60:63]
    ds_read_b128 v[188:191], v192 offset:3584
    global_load_dwordx4 a[32:35], v2, s[26:27] offset:0 sc1
    v_mfma_f32_16x16x32_bf16 v[60:63], v[92:95], v[96:99], v[60:63]
    s_nop 0
    s_waitcnt lgkmcnt(0)
    v_mfma_f32_16x16x32_bf16 v[48:51], v[136:139], v[168:171], v[48:51]
    global_load_dwordx4 a[36:39], v2, s[26:27] offset:1024 sc1
    v_mfma_f32_16x16x32_bf16 v[48:51], v[132:135], v[172:175], v[48:51]
    ds_read_b64 v[16:17], v193 offset:10880
    v_mfma_f32_16x16x32_bf16 v[52:55], v[136:139], v[172:175], v[52:55]
    ds_read_b64 v[18:19], v193 offset:11392
    v_mfma_f32_16x16x32_bf16 v[48:51], v[140:143], v[164:167], v[48:51]
    ds_read_b64 v[20:21], v202 offset:44288
    global_load_dwordx4 a[40:43], v2, s[26:27] offset:2048 sc1
    v_mfma_f32_16x16x32_bf16 v[52:55], v[140:143], v[168:171], v[52:55]
    ds_read_b64 v[22:23], v202 offset:44800
    v_mfma_f32_16x16x32_bf16 v[56:59], v[140:143], v[172:175], v[56:59]
    v_mfma_f32_16x16x32_bf16 v[48:51], v[128:131], v[176:179], v[48:51]
    global_load_dwordx4 a[44:47], v2, s[26:27] offset:3072 sc1
    s_add_u32 s26, s26, 4096
    s_nop 0
    s_addc_u32 s27, s27, 0
    v_mfma_f32_16x16x32_bf16 v[52:55], v[132:135], v[176:179], v[52:55]
    v_mfma_f32_16x16x32_bf16 v[56:59], v[136:139], v[176:179], v[56:59]
    v_mfma_f32_16x16x32_bf16 v[60:63], v[140:143], v[176:179], v[60:63]
    global_load_dwordx4 a[48:51], v2, s[26:27] offset:0 sc1
    v_mfma_f32_16x16x32_bf16 v[48:51], v[144:147], v[160:163], v[48:51]
    v_mfma_f32_16x16x32_bf16 v[52:55], v[144:147], v[164:167], v[52:55]
    v_mfma_f32_16x16x32_bf16 v[56:59], v[144:147], v[168:171], v[56:59]
    global_load_dwordx4 a[52:55], v2, s[26:27] offset:1024 sc1
    v_mfma_f32_16x16x32_bf16 v[60:63], v[144:147], v[172:175], v[60:63]
    v_mfma_f32_16x16x32_bf16 v[52:55], v[128:131], v[180:183], v[52:55]
    v_mfma_f32_16x16x32_bf16 v[56:59], v[132:135], v[180:183], v[56:59]
    global_load_dwordx4 a[56:59], v2, s[26:27] offset:2048 sc1
    v_mfma_f32_16x16x32_bf16 v[60:63], v[136:139], v[180:183], v[60:63]
    v_mfma_f32_16x16x32_bf16 v[52:55], v[148:151], v[160:163], v[52:55]
    v_mfma_f32_16x16x32_bf16 v[56:59], v[148:151], v[164:167], v[56:59]
    global_load_dwordx4 a[60:63], v2, s[26:27] offset:3072 sc1
    s_add_u32 s26, s26, 4096
    s_nop 0
    s_addc_u32 s27, s27, 0
    v_mfma_f32_16x16x32_bf16 v[60:63], v[148:151], v[168:171], v[60:63]
    v_mfma_f32_16x16x32_bf16 v[56:59], v[128:131], v[184:187], v[56:59]
    v_mfma_f32_16x16x32_bf16 v[60:63], v[132:135], v[184:187], v[60:63]
    global_load_dwordx4 a[64:67], v2, s[26:27] offset:0 sc1
    v_mfma_f32_16x16x32_bf16 v[56:59], v[152:155], v[160:163], v[56:59]
    v_mfma_f32_16x16x32_bf16 v[60:63], v[152:155], v[164:167], v[60:63]
    v_mfma_f32_16x16x32_bf16 v[60:63], v[128:131], v[188:191], v[60:63]
    global_load_dwordx4 a[68:71], v2, s[26:27] offset:1024 sc1
    v_mfma_f32_16x16x32_bf16 v[60:63], v[156:159], v[160:163], v[60:63]
    s_nop 7
    s_cmp_eq_u32 s54, 0
    s_cbranch_scc0 L_cvB_1
    ds_write_b128 v198, v[56:59] offset:14976
    ds_write_b128 v198, v[60:63] offset:16000
    v_mov_b64 v[224:225], v[48:49]
    v_mov_b64 v[226:227], v[50:51]
    v_mov_b64 v[228:229], v[52:53]
    v_mov_b64 v[230:231], v[54:55]
    s_branch L_cvB_2
L_cvB_1:
    ds_write_b128 v198, v[48:51] offset:14976
    ds_write_b128 v198, v[52:55] offset:16000
    v_mov_b64 v[224:225], v[56:57]
    v_mov_b64 v[226:227], v[58:59]
    v_mov_b64 v[228:229], v[60:61]
    v_mov_b64 v[230:231], v[62:63]
L_cvB_2:
    s_waitcnt lgkmcnt(0)
    s_barrier
    v_lshlrev_b32_e64 v160, 4, v0
    v_add_u32 v160, 0x860000, v160
    global_load_dwordx4 v[164:167], v160, s[48:49] sc1
    ds_read_b128 v[232:235], v199 offset:14976
    ds_read_b128 v[236:239], v199 offset:16000
    v_lshlrev_b32 v240, 16, v16
    v_and_b32 v241, s58, v16
    v_pk_fma_f32 v[224:225], v[240:241], s[74:75], v[224:225] op_sel_hi:[1,0,1]
    v_lshlrev_b32 v248, 16, v20
    v_and_b32 v249, s58, v20
    v_lshlrev_b32 v242, 16, v17
    v_and_b32 v243, s58, v17
    v_pk_fma_f32 v[226:227], v[242:243], s[74:75], v[226:227] op_sel_hi:[1,0,1]
    v_lshlrev_b32 v250, 16, v21
    v_and_b32 v251, s58, v21
    v_lshlrev_b32 v244, 16, v18
    v_and_b32 v245, s58, v18
    v_pk_fma_f32 v[228:229], v[244:245], s[74:75], v[228:229] op_sel_hi:[1,0,1]
    v_lshlrev_b32 v252, 16, v22
    v_and_b32 v253, s58, v22
    v_lshlrev_b32 v246, 16, v19
    v_and_b32 v247, s58, v19
    v_pk_fma_f32 v[230:231], v[246:247], s[74:75], v[230:231] op_sel_hi:[1,0,1]
    v_lshlrev_b32_e64 v254, 16, v23
    v_and_b32 v255, s58, v23
    s_waitcnt lgkmcnt(0)
    v_pk_add_f32 v[224:225], v[224:225], v[232:233]
    v_pk_fma_f32 v[224:225], v[224:225], s[74:75], v[248:249] op_sel:[0,1,0] op_sel_hi:[1,1,1]
    v_pk_mul_f32 v[240:241], v[224:225], s[76:77] op_sel_hi:[1,0]
    v_cvt_pk_bf16_f32 v24, v240, v241
    v_cvt_pk_bf16_f32 v28, v224, v225
    v_pk_add_f32 v[226:227], v[226:227], v[234:235]
    v_pk_fma_f32 v[226:227], v[226:227], s[74:75], v[250:251] op_sel:[0,1,0] op_sel_hi:[1,1,1]
    v_pk_mul_f32 v[242:243], v[226:227], s[76:77] op_sel_hi:[1,0]
    v_cvt_pk_bf16_f32 v25, v242, v243
    v_cvt_pk_bf16_f32 v29, v226, v227
    v_pk_add_f32 v[228:229], v[228:229], v[236:237]
    v_pk_fma_f32 v[228:229], v[228:229], s[74:75], v[252:253] op_sel:[0,1,0] op_sel_hi:[1,1,1]
    v_pk_mul_f32 v[244:245], v[228:229], s[76:77] op_sel_hi:[1,0]
    v_cvt_pk_bf16_f32 v26, v244, v245
    v_cvt_pk_bf16_f32 v30, v228, v229
    v_pk_add_f32 v[230:231], v[230:231], v[238:239]
    v_pk_fma_f32 v[230:231], v[230:231], s[74:75], v[254:255] op_sel:[0,1,0] op_sel_hi:[1,1,1]
    v_pk_mul_f32 v[246:247], v[230:231], s[76:77] op_sel_hi:[1,0]
    v_cvt_pk_bf16_f32 v27, v246, v247
    v_cvt_pk_bf16_f32 v31, v230, v231
    v_permlane16_swap_b32 v24, v26
    v_permlane16_swap_b32 v25, v27
    global_store_dwordx4 v201, v[24:27], s[68:69] sc1
    v_permlane16_swap_b32 v28, v30
    v_permlane16_swap_b32 v29, v31
    global_store_dwordx4 v201, v[28:31], s[66:67] sc1
    s_cmp_lg_u32 s50, 1
    s_cbranch_scc1 L_f2a_i
    global_load_dwordx4 v[72:75], v218, s[14:15] sc1
L_f2a_i:
    global_load_dwordx4 a[72:75], v2, s[26:27] offset:2048 sc1
    global_load_dwordx4 a[76:79], v2, s[26:27] offset:3072 sc1
    s_add_u32 s26, s26, 4096
    s_addc_u32 s27, s27, 0
    global_load_dwordx4 a[80:83], v2, s[26:27] offset:0 sc1
    global_load_dwordx4 a[84:87], v2, s[26:27] offset:1024 sc1
    global_load_dwordx4 a[88:91], v2, s[26:27] offset:2048 sc1
    global_load_dwordx4 a[92:95], v2, s[26:27] offset:3072 sc1
    s_add_u32 s26, s26, 4096
    s_addc_u32 s27, s27, 0
    global_load_dwordx4 a[96:99], v2, s[26:27] offset:0 sc1
    global_load_dwordx4 a[100:103], v2, s[26:27] offset:1024 sc1
    global_load_dwordx4 a[104:107], v2, s[26:27] offset:2048 sc1
    global_load_dwordx4 a[108:111], v2, s[26:27] offset:3072 sc1
    s_add_u32 s26, s26, 4096
    s_nop 0
    s_addc_u32 s27, s27, 0
    global_load_dwordx4 a[112:115], v2, s[26:27] offset:0 sc1
    global_load_dwordx4 a[116:119], v2, s[26:27] offset:1024 sc1
    global_load_dwordx4 a[120:123], v2, s[26:27] offset:2048 sc1
    global_load_dwordx4 a[124:127], v2, s[26:27] offset:3072 sc1
    v_add_u32 v126, 0x2000, v218
    s_lshl_b32 s8, s3, 2
    s_lshr_b32 s9, s4, 3
    s_add_u32 s8, s8, s9
    s_and_b32 s9, s4, 7
    v_add_u32 v113, 114688, v2
    s_mul_i32 s51, s50, 28672
    s_mul_i32 s60, s8, 114688
    s_add_u32 s60, s60, s51
    s_add_u32 s22, s60, 0x1000000
    s_add_u32 s22, s48, s22
    s_addc_u32 s23, s49, 0
    v_lshrrev_b32 v8, 5, v1
    v_mul_u32_u24_e64 v8, 8, v8
    v_bfe_u32 v9, v1, 2, 2
    v_add_u32 v8, v8, v9
    v_lshlrev_b32 v4, 6, v8
    v_bfe_u32 v8, v1, 4, 1
    v_lshl_add_u32 v4, v8, 5, v4
    v_and_b32_e64 v8, 3, v1
    v_lshl_add_u32 v4, v8, 3, v4
    v_add_u32 v5, 0x10000, v4
    v_and_b32 v6, 31, v1
    v_lshlrev_b32 v6, 3, v6
    s_mul_i32 s62, s5, 229376
    s_lshl_b32 s63, s6, 11
    s_add_u32 s62, s62, s63
    s_add_u32 s68, s62, 0x1000000
    s_add_u32 s68, s48, s68
    s_addc_u32 s69, s49, 0
    s_lshl_b32 s62, s5, 9
    s_add_u32 s70, s14, s62
    s_addc_u32 s71, s15, 0
    v_bfe_u32 v16, v1, 4, 1
    v_xor_b32 v16, 1, v16
    v_lshlrev_b32 v16, 10, v16
    v_lshrrev_b32 v17, 5, v1
    v_lshl_add_u32 v16, v17, 4, v16
    v_add_u32 v16, 145408, v16
    v_lshlrev_b32_e64 v17, 2, v0
    v_add_u32 v17, 145408, v17
    v_lshlrev_b32_e64 v18, 3, v0
    v_add_u32 v18, 147456, v18
    v_lshrrev_b32 v119, 5, v1
    v_and_b32 v118, 31, v1
    v_lshlrev_b32_e64 v116, 8, v119
    v_lshl_add_u32 v116, v118, 1, v116
    v_lshlrev_b32_e64 v117, 4, v119
    v_lshl_add_u32 v118, v118, 10, v117
    s_lshl_b32 s62, s9, 2
    s_add_u32 s62, s62, s50
    s_lshl_b32 s63, s8, 15
    s_lshl_b32 s60, s62, 10
    s_add_u32 s60, s60, s63
    s_add_u32 s20, s60, 0xd00000
    s_add_u32 s20, s48, s20
    s_addc_u32 s21, s49, 0
    s_lshl_b32 s60, s62, 6
    s_add_u32 s60, s60, 147456
    v_add_u32 v117, s60, v117
    s_lshl_b32 s60, s62, 5
    s_add_u32 s60, s60, s63
    s_add_u32 s24, s44, s60
    s_addc_u32 s25, s45, 0
    s_lshl_b32 s60, s50, 13
    v_add_u32 v120, s60, v2
    s_lshl_b32 s60, s50, 11
    v_add_u32_e64 v121, s60, v2
    s_lshr_b32 s60, s8, 1
    s_lshl_b32 s60, s60, 6
    s_add_u32 s60, s60, 0xc000
    v_min_u32_e64 v122, 13, v1
    v_lshl_add_u32 v122, v122, 2, s60
    s_lshl_b32 s10, s5, 6
    s_lshl_b32 s61, s7, 2
    s_add_u32 s10, s10, s61
    s_mov_b32 s80, 0
    s_waitcnt vmcnt(16)
L_fin_p:
    v_cmp_ne_u32 vcc, s81, v167
    s_nop 0
    s_cbranch_vccz L_fin_w
    s_add_u32 s80, s80, 1
    s_cmp_gt_u32 s80, 0x80000
    s_cbranch_scc1 L_fin_w
    global_load_dwordx4 v[164:167], v160, s[48:49] sc1
    s_waitcnt vmcnt(0)
    s_branch L_fin_p
L_fin_w:
    v_lshlrev_b32_e64 v168, 16, v166
    v_and_b32 v169, 0xffff0000, v166
    v_mul_f32 v168, 0xbf317218, v168
    v_mul_f32 v169, 0xbf317218, v169
    ds_write2st64_b32 v17, v164, v165 offset0:0 offset1:4
    ds_write_b64 v18, v[168:169]
    s_waitcnt lgkmcnt(0)
    s_waitcnt vmcnt(14)
    s_barrier
    s_cmp_lg_u32 s50, 1
    s_cbranch_scc1 L_f2b_s
    s_lshl_b32 s80, s2, 2
    s_add_u32 s80, s80, 0xa000
    v_lshl_add_u32 v19, v1, 10, s80
    v_mov_b32_e64 v20, s81
    s_mov_b64 exec, 255
    global_store_dword v19, v20, s[14:15] sc1
    s_mov_b64 exec, -1
L_f2b_s:
    s_cmp_lg_u32 s50, 1
    s_cbranch_scc1 L_f2a_w
    s_mov_b32 s80, 0
    s_waitcnt vmcnt(15)
L_f2a_p:
    v_xor_b32 v114, s81, v72
    v_xor_b32 v115, s81, v73
    v_or_b32 v114, v114, v115
    v_xor_b32 v115, s81, v74
    v_or_b32 v114, v114, v115
    v_xor_b32 v115, s81, v75
    v_or_b32 v114, v114, v115
    v_cmp_ne_u32 vcc, 0, v114
    s_nop 0
    s_cbranch_vccz L_f2a_w
    s_add_u32 s80, s80, 1
    s_cmp_gt_u32 s80, 0x80000
    s_cbranch_scc1 L_f2a_w
    s_sleep 1
    global_load_dwordx4 v[72:75], v218, s[14:15] sc1
    s_waitcnt vmcnt(0)
    s_branch L_f2a_p
L_f2a_w:
    s_barrier
    s_cmp_ge_u32 s4, 28
    s_cbranch_scc1 L_st_a
    s_add_u32 m0, s56, 0
    s_nop 0
    global_load_lds_dwordx4 v2, s[28:29] offset:0 sc1
    global_load_lds_dwordx4 v2, s[28:29] offset:1024 sc1
    global_load_lds_dwordx4 v2, s[28:29] offset:2048 sc1
    global_load_lds_dwordx4 v2, s[28:29] offset:3072 sc1
    s_branch L_st_b
L_st_a:
    s_sub_u32 s11, s4, 28
    s_lshl_b32 s60, s3, 2
    s_add_u32 s11, s11, s60
    s_lshl_b32 s60, s11, 15
    s_lshl_b32 s61, s50, 13
    s_add_u32 s60, s60, s61
    s_add_u32 s28, s60, 0xd00000
    s_add_u32 s28, s48, s28
    s_addc_u32 s29, s49, 0
    v_add_u32 v7, 0x1000, v2
    global_load_dwordx4 v[80:83], v2, s[28:29] offset:0 sc1
    global_load_dwordx4 v[84:87], v2, s[28:29] offset:1024 sc1
    global_load_dwordx4 v[88:91], v2, s[28:29] offset:2048 sc1
    global_load_dwordx4 v[92:95], v2, s[28:29] offset:3072 sc1
    global_load_dwordx4 v[96:99], v7, s[28:29] offset:0 sc1
    global_load_dwordx4 v[100:103], v7, s[28:29] offset:1024 sc1
    global_load_dwordx4 v[104:107], v7, s[28:29] offset:2048 sc1
    global_load_dwordx4 v[108:111], v7, s[28:29] offset:3072 sc1
    s_nop 0
    s_branch L_stats
L_st_b:
    ds_read_b128 v[80:83], v16 offset:0
    ds_read_b128 v[84:87], v16 offset:32
    ds_read_b128 v[88:91], v16 offset:64
    ds_read_b128 v[92:95], v16 offset:96
    ds_read_b128 v[96:99], v16 offset:128
    ds_read_b128 v[100:103], v16 offset:160
    ds_read_b128 v[104:107], v16 offset:192
    ds_read_b128 v[108:111], v16 offset:224
    s_waitcnt lgkmcnt(7)
    v_mfma_f32_32x32x16_bf16 v[128:143], a[0:3], v[80:83], 0
    s_add_u32 s28, s28, 8192
    s_addc_u32 s29, s29, 0
    s_waitcnt lgkmcnt(6)
    v_mfma_f32_32x32x16_bf16 v[128:143], a[4:7], v[84:87], v[128:143]
    s_add_u32 m0, s56, 8192
    ds_read_b128 v[80:83], v16 offset:256
    s_waitcnt lgkmcnt(6)
    v_mfma_f32_32x32x16_bf16 v[128:143], a[8:11], v[88:91], v[128:143]
    global_load_lds_dwordx4 v2, s[28:29] offset:0 sc1
    ds_read_b128 v[84:87], v16 offset:288
    s_waitcnt lgkmcnt(6)
    v_mfma_f32_32x32x16_bf16 v[128:143], a[12:15], v[92:95], v[128:143]
    global_load_lds_dwordx4 v2, s[28:29] offset:1024 sc1
    ds_read_b128 v[88:91], v16 offset:320
    s_waitcnt lgkmcnt(6)
    v_mfma_f32_32x32x16_bf16 v[128:143], a[16:19], v[96:99], v[128:143]
    global_load_lds_dwordx4 v2, s[28:29] offset:2048 sc1
    ds_read_b128 v[92:95], v16 offset:352
    s_waitcnt lgkmcnt(6)
    v_mfma_f32_32x32x16_bf16 v[128:143], a[20:23], v[100:103], v[128:143]
    global_load_lds_dwordx4 v2, s[28:29] offset:3072 sc1
    ds_read_b128 v[96:99], v16 offset:384
    s_waitcnt lgkmcnt(6)
    v_mfma_f32_32x32x16_bf16 v[128:143], a[24:27], v[104:107], v[128:143]
    s_add_u32 s28, s28, 8192
    s_addc_u32 s29, s29, 0
    ds_read_b128 v[100:103], v16 offset:416
    s_waitcnt lgkmcnt(6)
    v_mfma_f32_32x32x16_bf16 v[128:143], a[28:31], v[108:111], v[128:143]
    s_add_u32 m0, s56, 16384
    ds_read_b128 v[104:107], v16 offset:448
    s_waitcnt lgkmcnt(6)
    v_mfma_f32_32x32x16_bf16 v[128:143], a[32:35], v[80:83], v[128:143]
    global_load_lds_dwordx4 v2, s[28:29] offset:0 sc1
    ds_read_b128 v[108:111], v16 offset:480
    s_waitcnt lgkmcnt(6)
    v_mfma_f32_32x32x16_bf16 v[128:143], a[36:39], v[84:87], v[128:143]
    global_load_lds_dwordx4 v2, s[28:29] offset:1024 sc1
    ds_read_b128 v[80:83], v16 offset:512
    s_waitcnt lgkmcnt(6)
    v_mfma_f32_32x32x16_bf16 v[128:143], a[40:43], v[88:91], v[128:143]
    global_load_lds_dwordx4 v2, s[28:29] offset:2048 sc1
    ds_read_b128 v[84:87], v16 offset:544
    s_waitcnt lgkmcnt(6)
    v_mfma_f32_32x32x16_bf16 v[128:143], a[44:47], v[92:95], v[128:143]
    global_load_lds_dwordx4 v2, s[28:29] offset:3072 sc1
    ds_read_b128 v[88:91], v16 offset:576
    s_waitcnt lgkmcnt(6)
    v_mfma_f32_32x32x16_bf16 v[128:143], a[48:51], v[96:99], v[128:143]
    s_add_u32 s28, s28, 8192
    s_addc_u32 s29, s29, 0
    ds_read_b128 v[92:95], v16 offset:608
    s_waitcnt lgkmcnt(6)
    v_mfma_f32_32x32x16_bf16 v[128:143], a[52:55], v[100:103], v[128:143]
    s_add_u32 m0, s56, 24576
    ds_read_b128 v[96:99], v16 offset:640
    s_waitcnt lgkmcnt(6)
    v_mfma_f32_32x32x16_bf16 v[128:143], a[56:59], v[104:107], v[128:143]
    global_load_lds_dwordx4 v2, s[28:29] offset:0 sc1
    ds_read_b128 v[100:103], v16 offset:672
    s_waitcnt lgkmcnt(6)
    v_mfma_f32_32x32x16_bf16 v[128:143], a[60:63], v[108:111], v[128:143]
    global_load_lds_dwordx4 v2, s[28:29] offset:1024 sc1
    ds_read_b128 v[104:107], v16 offset:704
    s_waitcnt lgkmcnt(6)
    v_mfma_f32_32x32x16_bf16 v[128:143], a[64:67], v[80:83], v[128:143]
    global_load_lds_dwordx4 v2, s[28:29] offset:2048 sc1
    ds_read_b128 v[108:111], v16 offset:736
    s_waitcnt lgkmcnt(6)
    v_mfma_f32_32x32x16_bf16 v[128:143], a[68:71], v[84:87], v[128:143]
    global_load_lds_dwordx4 v2, s[28:29] offset:3072 sc1
    ds_read_b128 v[80:83], v16 offset:768
    s_waitcnt vmcnt(29) lgkmcnt(6)
    v_mfma_f32_32x32x16_bf16 v[128:143], a[72:75], v[88:91], v[128:143]
    s_add_u32 s28, s28, 1024000
    s_addc_u32 s29, s29, 0
    ds_read_b128 v[84:87], v16 offset:800
    s_waitcnt vmcnt(28) lgkmcnt(6)
    v_mfma_f32_32x32x16_bf16 v[128:143], a[76:79], v[92:95], v[128:143]
    global_load_dwordx4 a[128:131], v2, s[32:33] offset:0 sc1
    ds_read_b128 v[88:91], v16 offset:832
    s_waitcnt vmcnt(28) lgkmcnt(6)
    v_mfma_f32_32x32x16_bf16 v[128:143], a[80:83], v[96:99], v[128:143]
    global_load_dwordx4 a[132:135], v113, s[32:33] offset:0 sc1
    ds_read_b128 v[92:95], v16 offset:864
    s_waitcnt vmcnt(28) lgkmcnt(6)
    v_mfma_f32_32x32x16_bf16 v[128:143], a[84:87], v[100:103], v[128:143]
    global_load_dwordx4 a[136:139], v2, s[32:33] offset:1024 sc1
    ds_read_b128 v[96:99], v16 offset:896
    s_waitcnt vmcnt(28) lgkmcnt(6)
    v_mfma_f32_32x32x16_bf16 v[128:143], a[88:91], v[104:107], v[128:143]
    global_load_dwordx4 a[140:143], v113, s[32:33] offset:1024 sc1
    ds_read_b128 v[100:103], v16 offset:928
    s_waitcnt vmcnt(28) lgkmcnt(6)
    v_mfma_f32_32x32x16_bf16 v[128:143], a[92:95], v[108:111], v[128:143]
    global_load_dwordx4 a[144:147], v2, s[32:33] offset:2048 sc1
    ds_read_b128 v[104:107], v16 offset:960
    s_waitcnt vmcnt(28) lgkmcnt(6)
    v_mfma_f32_32x32x16_bf16 v[128:143], a[96:99], v[80:83], v[128:143]
    global_load_dwordx4 a[148:151], v113, s[32:33] offset:2048 sc1
    ds_read_b128 v[108:111], v16 offset:992
    s_waitcnt vmcnt(28) lgkmcnt(6)
    v_mfma_f32_32x32x16_bf16 v[128:143], a[100:103], v[84:87], v[128:143]
    global_load_dwordx4 a[152:155], v2, s[32:33] offset:3072 sc1
    s_waitcnt vmcnt(28) lgkmcnt(5)
    v_mfma_f32_32x32x16_bf16 v[128:143], a[104:107], v[88:91], v[128:143]
    global_load_dwordx4 a[156:159], v113, s[32:33] offset:3072 sc1
    s_waitcnt vmcnt(28) lgkmcnt(4)
    v_mfma_f32_32x32x16_bf16 v[128:143], a[108:111], v[92:95], v[128:143]
    s_add_u32 s32, s32, 4096
    s_addc_u32 s33, s33, 0
    s_waitcnt vmcnt(27) lgkmcnt(3)
    v_mfma_f32_32x32x16_bf16 v[128:143], a[112:115], v[96:99], v[128:143]
    global_load_dwordx4 a[160:163], v2, s[32:33] offset:0 sc1
    s_waitcnt vmcnt(27) lgkmcnt(2)
    v_mfma_f32_32x32x16_bf16 v[128:143], a[116:119], v[100:103], v[128:143]
    global_load_dwordx4 a[164:167], v113, s[32:33] offset:0 sc1
    s_waitcnt vmcnt(27) lgkmcnt(1)
    v_mfma_f32_32x32x16_bf16 v[128:143], a[120:123], v[104:107], v[128:143]
    global_load_dwordx4 a[168:171], v2, s[32:33] offset:1024 sc1
    s_nop 0
    s_waitcnt vmcnt(27) lgkmcnt(0)
    v_mfma_f32_32x32x16_bf16 v[128:143], a[124:127], v[108:111], v[128:143]
    global_load_dwordx4 a[172:175], v113, s[32:33] offset:1024 sc1
    s_waitcnt vmcnt(24)
    s_barrier
    ds_read_b64_tr_b16 v[48:49], v4 offset:0
    ds_read_b64_tr_b16 v[50:51], v4 offset:256
    ds_read_b64_tr_b16 v[52:53], v4 offset:32768
    ds_read_b64_tr_b16 v[54:55], v4 offset:33024
    ds_read_b64_tr_b16 v[56:57], v4 offset:1024
    ds_read_b64_tr_b16 v[58:59], v4 offset:1280
    ds_read_b64_tr_b16 v[60:61], v4 offset:33792
    ds_read_b64_tr_b16 v[62:63], v4 offset:34048
    s_waitcnt lgkmcnt(6)
    v_mfma_f32_32x32x16_bf16 v[16:31], a[0:3], v[48:51], 0
    ds_read_b64_tr_b16 v[64:65], v4 offset:2048
    ds_read_b64_tr_b16 v[66:67], v4 offset:2304
    global_load_dwordx4 a[176:179], v2, s[32:33] offset:2048 sc1
    s_waitcnt lgkmcnt(6)
    v_mfma_f32_32x32x16_bf16 v[32:47], a[0:3], v[52:55], 0
    ds_read_b64_tr_b16 v[68:69], v4 offset:34816
    ds_read_b64_tr_b16 v[70:71], v4 offset:35072
    s_waitcnt lgkmcnt(6)
    v_mfma_f32_32x32x16_bf16 v[16:31], a[4:7], v[56:59], v[16:31]
    ds_read_b64_tr_b16 v[48:49], v4 offset:3072
    ds_read_b64_tr_b16 v[50:51], v4 offset:3328
    global_load_dwordx4 a[180:183], v113, s[32:33] offset:2048 sc1
    s_waitcnt lgkmcnt(6)
    v_mfma_f32_32x32x16_bf16 v[32:47], a[4:7], v[60:63], v[32:47]
    ds_read_b64_tr_b16 v[52:53], v4 offset:35840
    ds_read_b64_tr_b16 v[54:55], v4 offset:36096
    s_cmp_lg_u32 s50, 1
    s_cbranch_scc1 L_f2b_i
    global_load_dwordx4 v[72:75], v126, s[14:15] sc1
L_f2b_i:
    s_waitcnt lgkmcnt(6)
    v_mfma_f32_32x32x16_bf16 v[16:31], a[8:11], v[64:67], v[16:31]
    ds_read_b64_tr_b16 v[56:57], v4 offset:4096
    ds_read_b64_tr_b16 v[58:59], v4 offset:4352
    v_mov_b32 v144, v128
    v_mov_b32 v145, v129
    global_load_dwordx4 a[184:187], v2, s[32:33] offset:3072 sc1
    s_waitcnt lgkmcnt(6)
    v_mfma_f32_32x32x16_bf16 v[32:47], a[8:11], v[68:71], v[32:47]
    ds_read_b64_tr_b16 v[60:61], v4 offset:36864
    ds_read_b64_tr_b16 v[62:63], v4 offset:37120
    v_mov_b32_e64 v146, v130
    v_mov_b32 v147, v131
    s_waitcnt lgkmcnt(6)
    v_mfma_f32_32x32x16_bf16 v[16:31], a[12:15], v[48:51], v[16:31]
    ds_read_b64_tr_b16 v[64:65], v4 offset:5120
    ds_read_b64_tr_b16 v[66:67], v4 offset:5376
    v_mov_b32_e64 v148, v132
    v_mov_b32 v149, v133
    global_load_dwordx4 a[188:191], v113, s[32:33] offset:3072 sc1
    s_waitcnt lgkmcnt(6)
    v_mfma_f32_32x32x16_bf16 v[32:47], a[12:15], v[52:55], v[32:47]
    ds_read_b64_tr_b16 v[68:69], v4 offset:37888
    ds_read_b64_tr_b16 v[70:71], v4 offset:38144
    v_mov_b32_e64 v150, v134
    v_mov_b32 v151, v135
    s_waitcnt lgkmcnt(6)
    v_mfma_f32_32x32x16_bf16 v[16:31], a[16:19], v[56:59], v[16:31]
    ds_read_b64_tr_b16 v[48:49], v4 offset:6144
    ds_read_b64_tr_b16 v[50:51], v4 offset:6400
    v_mov_b32 v152, v136
    v_mov_b32 v153, v137
    s_add_u32 s32, s32, 4096
    s_addc_u32 s33, s33, 0
    s_waitcnt lgkmcnt(6)
    v_mfma_f32_32x32x16_bf16 v[32:47], a[16:19], v[60:63], v[32:47]
    ds_read_b64_tr_b16 v[52:53], v4 offset:38912
    ds_read_b64_tr_b16 v[54:55], v4 offset:39168
    v_mov_b32_e64 v154, v138
    v_mov_b32 v155, v139
    s_waitcnt lgkmcnt(6)
    v_mfma_f32_32x32x16_bf16 v[16:31], a[20:23], v[64:67], v[16:31]
    ds_read_b64_tr_b16 v[56:57], v4 offset:7168
    ds_read_b64_tr_b16 v[58:59], v4 offset:7424
    v_mov_b32_e64 v156, v140
    v_mov_b32 v157, v141
    global_load_dwordx4 a[192:195], v2, s[32:33] offset:0 sc1
    s_waitcnt lgkmcnt(6)
    v_mfma_f32_32x32x16_bf16 v[32:47], a[20:23], v[68:71], v[32:47]
    ds_read_b64_tr_b16 v[60:61], v4 offset:39936
    ds_read_b64_tr_b16 v[62:63], v4 offset:40192
    v_mov_b32_e64 v158, v142
    v_mov_b32 v159, v143
    s_waitcnt vmcnt(25)
    s_barrier
    s_waitcnt lgkmcnt(6)
    v_mfma_f32_32x32x16_bf16 v[16:31], a[24:27], v[48:51], v[16:31]
    ds_read_b64_tr_b16 v[64:65], v4 offset:8192
    ds_read_b64_tr_b16 v[66:67], v4 offset:8448
    v_permlane16_swap_b32 v128, v144
    v_permlane16_swap_b32 v129, v145
    global_load_dwordx4 a[196:199], v113, s[32:33] offset:0 sc1
    s_waitcnt lgkmcnt(6)
    v_mfma_f32_32x32x16_bf16 v[32:47], a[24:27], v[52:55], v[32:47]
    ds_read_b64_tr_b16 v[68:69], v4 offset:40960
    ds_read_b64_tr_b16 v[70:71], v4 offset:41216
    v_permlane16_swap_b32 v130, v146
    v_permlane16_swap_b32 v131, v147
    s_waitcnt lgkmcnt(6)
    v_mfma_f32_32x32x16_bf16 v[16:31], a[28:31], v[56:59], v[16:31]
    ds_read_b64_tr_b16 v[48:49], v4 offset:9216
    ds_read_b64_tr_b16 v[50:51], v4 offset:9472
    v_permlane16_swap_b32 v132, v148
    v_permlane16_swap_b32 v133, v149
    global_load_dwordx4 a[200:203], v2, s[32:33] offset:1024 sc1
    s_waitcnt lgkmcnt(6)
    v_mfma_f32_32x32x16_bf16 v[32:47], a[28:31], v[60:63], v[32:47]
    ds_read_b64_tr_b16 v[52:53], v4 offset:41984
    ds_read_b64_tr_b16 v[54:55], v4 offset:42240
    v_permlane16_swap_b32 v134, v150
    v_permlane16_swap_b32 v135, v151
    s_waitcnt lgkmcnt(6)
    v_mfma_f32_32x32x16_bf16 v[16:31], a[32:35], v[64:67], v[16:31]
    ds_read_b64_tr_b16 v[56:57], v4 offset:10240
    ds_read_b64_tr_b16 v[58:59], v4 offset:10496
    v_permlane16_swap_b32 v136, v152
    v_permlane16_swap_b32 v137, v153
    global_load_dwordx4 a[204:207], v113, s[32:33] offset:1024 sc1
    s_waitcnt lgkmcnt(6)
    v_mfma_f32_32x32x16_bf16 v[32:47], a[32:35], v[68:71], v[32:47]
    ds_read_b64_tr_b16 v[60:61], v4 offset:43008
    ds_read_b64_tr_b16 v[62:63], v4 offset:43264
    v_permlane16_swap_b32 v138, v154
    v_permlane16_swap_b32 v139, v155
    s_waitcnt lgkmcnt(6)
    v_mfma_f32_32x32x16_bf16 v[16:31], a[36:39], v[48:51], v[16:31]
    ds_read_b64_tr_b16 v[64:65], v4 offset:11264
    ds_read_b64_tr_b16 v[66:67], v4 offset:11520
    v_permlane16_swap_b32 v140, v156
    v_permlane16_swap_b32 v141, v157
    global_load_dwordx4 a[208:211], v2, s[32:33] offset:2048 sc1
    s_waitcnt lgkmcnt(6)
    v_mfma_f32_32x32x16_bf16 v[32:47], a[36:39], v[52:55], v[32:47]
    ds_read_b64_tr_b16 v[68:69], v4 offset:44032
    ds_read_b64_tr_b16 v[70:71], v4 offset:44288
    v_permlane16_swap_b32 v142, v158
    v_permlane16_swap_b32 v143, v159
    s_waitcnt lgkmcnt(6)
    v_mfma_f32_32x32x16_bf16 v[16:31], a[40:43], v[56:59], v[16:31]
    ds_read_b64_tr_b16 v[48:49], v4 offset:12288
    ds_read_b64_tr_b16 v[50:51], v4 offset:12544
    v_mul_f32 v144, 0xbfb8aa3b, v144
    v_mul_f32 v145, 0xbfb8aa3b, v145
    global_load_dwordx4 a[212:215], v113, s[32:33] offset:2048 sc1
    s_waitcnt lgkmcnt(6)
    v_mfma_f32_32x32x16_bf16 v[32:47], a[40:43], v[60:63], v[32:47]
    ds_read_b64_tr_b16 v[52:53], v4 offset:45056
    ds_read_b64_tr_b16 v[54:55], v4 offset:45312
    v_mul_f32 v146, 0xbfb8aa3b, v146
    v_mul_f32 v147, 0xbfb8aa3b, v147
    s_waitcnt lgkmcnt(6)
    v_mfma_f32_32x32x16_bf16 v[16:31], a[44:47], v[64:67], v[16:31]
    ds_read_b64_tr_b16 v[56:57], v4 offset:13312
    ds_read_b64_tr_b16 v[58:59], v4 offset:13568
    v_mul_f32 v148, 0xbfb8aa3b, v148
    v_mul_f32 v149, 0xbfb8aa3b, v149
    global_load_dwordx4 a[216:219], v2, s[32:33] offset:3072 sc1
    s_waitcnt lgkmcnt(6)
    v_mfma_f32_32x32x16_bf16 v[32:47], a[44:47], v[68:71], v[32:47]
    ds_read_b64_tr_b16 v[60:61], v4 offset:46080
    ds_read_b64_tr_b16 v[62:63], v4 offset:46336
    v_mul_f32 v150, 0xbfb8aa3b, v150
    v_mul_f32 v151, 0xbfb8aa3b, v151
    s_waitcnt lgkmcnt(6)
    v_mfma_f32_32x32x16_bf16 v[16:31], a[48:51], v[48:51], v[16:31]
    ds_read_b64_tr_b16 v[64:65], v4 offset:14336
    ds_read_b64_tr_b16 v[66:67], v4 offset:14592
    v_mul_f32 v152, 0xbfb8aa3b, v152
    v_mul_f32 v153, 0xbfb8aa3b, v153
    global_load_dwordx4 a[220:223], v113, s[32:33] offset:3072 sc1
    s_waitcnt lgkmcnt(6)
    v_mfma_f32_32x32x16_bf16 v[32:47], a[48:51], v[52:55], v[32:47]
    ds_read_b64_tr_b16 v[68:69], v4 offset:47104
    ds_read_b64_tr_b16 v[70:71], v4 offset:47360
    v_mul_f32 v154, 0xbfb8aa3b, v154
    v_mul_f32 v155, 0xbfb8aa3b, v155
    s_waitcnt lgkmcnt(6)
    v_mfma_f32_32x32x16_bf16 v[16:31], a[52:55], v[56:59], v[16:31]
    ds_read_b64_tr_b16 v[48:49], v4 offset:15360
    ds_read_b64_tr_b16 v[50:51], v4 offset:15616
    v_mul_f32 v156, 0xbfb8aa3b, v156
    v_mul_f32 v157, 0xbfb8aa3b, v157
    s_add_u32 s32, s32, 4096
    s_addc_u32 s33, s33, 0
    s_waitcnt lgkmcnt(6)
    v_mfma_f32_32x32x16_bf16 v[32:47], a[52:55], v[60:63], v[32:47]
    ds_read_b64_tr_b16 v[52:53], v4 offset:48128
    ds_read_b64_tr_b16 v[54:55], v4 offset:48384
    v_mul_f32 v158, 0xbfb8aa3b, v158
    v_mul_f32 v159, 0xbfb8aa3b, v159
    s_cmp_lg_u32 s50, 1
    s_cbranch_scc1 L_f2b_w
    s_mov_b32 s80, 0
    s_waitcnt vmcnt(10)
L_f2b_p:
    v_xor_b32 v80, s81, v72
    v_xor_b32 v81, s81, v73
    v_or_b32 v80, v80, v81
    v_xor_b32 v81, s81, v74
    v_or_b32 v80, v80, v81
    v_xor_b32 v81, s81, v75
    v_or_b32_e64 v80, v80, v81
    v_cmp_ne_u32 vcc, 0, v80
    s_nop 0
    s_cbranch_vccz L_f2b_w
    s_add_u32 s80, s80, 1
    s_cmp_gt_u32 s80, 0x80000
    s_cbranch_scc1 L_f2b_w
    s_sleep 1
    global_load_dwordx4 v[72:75], v126, s[14:15] sc1
    s_waitcnt vmcnt(0)
    s_branch L_f2b_p
L_f2b_w:
    s_waitcnt vmcnt(28)
    s_barrier
    s_waitcnt lgkmcnt(6)
    v_mfma_f32_32x32x16_bf16 v[16:31], a[56:59], v[64:67], v[16:31]
    ds_read_b64_tr_b16 v[56:57], v4 offset:16384
    ds_read_b64_tr_b16 v[58:59], v4 offset:16640
    s_add_u32 m0, s56, 65536
    s_waitcnt lgkmcnt(6)
    v_mfma_f32_32x32x16_bf16 v[32:47], a[56:59], v[68:71], v[32:47]
    ds_read_b64_tr_b16 v[60:61], v4 offset:49152
    ds_read_b64_tr_b16 v[62:63], v4 offset:49408
    global_load_lds_dwordx4 v2, s[28:29] offset:0 sc1
    s_waitcnt lgkmcnt(6)
    v_mfma_f32_32x32x16_bf16 v[16:31], a[60:63], v[48:51], v[16:31]
    ds_read_b64_tr_b16 v[64:65], v4 offset:17408
    ds_read_b64_tr_b16 v[66:67], v4 offset:17664
    global_load_lds_dwordx4 v2, s[28:29] offset:1024 sc1
    s_waitcnt lgkmcnt(6)
    v_mfma_f32_32x32x16_bf16 v[32:47], a[60:63], v[52:55], v[32:47]
    ds_read_b64_tr_b16 v[68:69], v4 offset:50176
    ds_read_b64_tr_b16 v[70:71], v4 offset:50432
    global_load_lds_dwordx4 v2, s[28:29] offset:2048 sc1
    s_waitcnt lgkmcnt(6)
    v_mfma_f32_32x32x16_bf16 v[16:31], a[64:67], v[56:59], v[16:31]
    ds_read_b64_tr_b16 v[48:49], v4 offset:18432
    ds_read_b64_tr_b16 v[50:51], v4 offset:18688
    global_load_lds_dwordx4 v2, s[28:29] offset:3072 sc1
    s_waitcnt lgkmcnt(6)
    v_mfma_f32_32x32x16_bf16 v[32:47], a[64:67], v[60:63], v[32:47]
    ds_read_b64_tr_b16 v[52:53], v4 offset:51200
    ds_read_b64_tr_b16 v[54:55], v4 offset:51456
    s_add_u32 s28, s28, 8192
    s_addc_u32 s29, s29, 0
    s_waitcnt lgkmcnt(6)
    v_mfma_f32_32x32x16_bf16 v[16:31], a[68:71], v[64:67], v[16:31]
    ds_read_b64_tr_b16 v[56:57], v4 offset:19456
    ds_read_b64_tr_b16 v[58:59], v4 offset:19712
    s_add_u32 m0, s56, 73728
    s_waitcnt lgkmcnt(6)
    v_mfma_f32_32x32x16_bf16 v[32:47], a[68:71], v[68:71], v[32:47]
    ds_read_b64_tr_b16 v[60:61], v4 offset:52224
    ds_read_b64_tr_b16 v[62:63], v4 offset:52480
    global_load_lds_dwordx4 v2, s[28:29] offset:0 sc1
    s_waitcnt lgkmcnt(6)
    v_mfma_f32_32x32x16_bf16 v[16:31], a[72:75], v[48:51], v[16:31]
    ds_read_b64_tr_b16 v[64:65], v4 offset:20480
    ds_read_b64_tr_b16 v[66:67], v4 offset:20736
    global_load_lds_dwordx4 v2, s[28:29] offset:1024 sc1
    s_waitcnt lgkmcnt(6)
    v_mfma_f32_32x32x16_bf16 v[32:47], a[72:75], v[52:55], v[32:47]
    ds_read_b64_tr_b16 v[68:69], v4 offset:53248
    ds_read_b64_tr_b16 v[70:71], v4 offset:53504
    global_load_lds_dwordx4 v2, s[28:29] offset:2048 sc1
    s_waitcnt lgkmcnt(6)
    v_mfma_f32_32x32x16_bf16 v[16:31], a[76:79], v[56:59], v[16:31]
    ds_read_b64_tr_b16 v[48:49], v4 offset:21504
    ds_read_b64_tr_b16 v[50:51], v4 offset:21760
    global_load_lds_dwordx4 v2, s[28:29] offset:3072 sc1
    s_nop 0
    s_waitcnt lgkmcnt(6)
    v_mfma_f32_32x32x16_bf16 v[32:47], a[76:79], v[60:63], v[32:47]
    ds_read_b64_tr_b16 v[52:53], v4 offset:54272
    ds_read_b64_tr_b16 v[54:55], v4 offset:54528
    s_add_u32 s28, s28, 8192
    s_addc_u32 s29, s29, 0
    s_waitcnt lgkmcnt(6)
    v_mfma_f32_32x32x16_bf16 v[16:31], a[80:83], v[64:67], v[16:31]
    ds_read_b64_tr_b16 v[56:57], v4 offset:22528
    ds_read_b64_tr_b16 v[58:59], v4 offset:22784
    s_add_u32 m0, s56, 81920
    s_waitcnt lgkmcnt(6)
    v_mfma_f32_32x32x16_bf16 v[32:47], a[80:83], v[68:71], v[32:47]
    ds_read_b64_tr_b16 v[60:61], v4 offset:55296
    ds_read_b64_tr_b16 v[62:63], v4 offset:55552
    global_load_lds_dwordx4 v2, s[28:29] offset:0 sc1
    s_waitcnt lgkmcnt(6)
    v_mfma_f32_32x32x16_bf16 v[16:31], a[84:87], v[48:51], v[16:31]
    ds_read_b64_tr_b16 v[64:65], v4 offset:23552
    ds_read_b64_tr_b16 v[66:67], v4 offset:23808
    global_load_lds_dwordx4 v2, s[28:29] offset:1024 sc1
    s_waitcnt lgkmcnt(6)
    v_mfma_f32_32x32x16_bf16 v[32:47], a[84:87], v[52:55], v[32:47]
    ds_read_b64_tr_b16 v[68:69], v4 offset:56320
    ds_read_b64_tr_b16 v[70:71], v4 offset:56576
    global_load_lds_dwordx4 v2, s[28:29] offset:2048 sc1
    s_waitcnt vmcnt(35)
    s_barrier
    s_waitcnt lgkmcnt(6)
    v_mfma_f32_32x32x16_bf16 v[16:31], a[88:91], v[56:59], v[16:31]
    ds_read_b64_tr_b16 v[48:49], v4 offset:24576
    ds_read_b64_tr_b16 v[50:51], v4 offset:24832
    global_load_lds_dwordx4 v2, s[28:29] offset:3072 sc1
    s_nop 0
    s_waitcnt lgkmcnt(6)
    v_mfma_f32_32x32x16_bf16 v[32:47], a[88:91], v[60:63], v[32:47]
    ds_read_b64_tr_b16 v[52:53], v4 offset:57344
    ds_read_b64_tr_b16 v[54:55], v4 offset:57600
    s_add_u32 s28, s28, 8192
    s_addc_u32 s29, s29, 0
    s_waitcnt lgkmcnt(6)
    v_mfma_f32_32x32x16_bf16 v[16:31], a[92:95], v[64:67], v[16:31]
    ds_read_b64_tr_b16 v[56:57], v4 offset:25600
    ds_read_b64_tr_b16 v[58:59], v4 offset:25856
    s_add_u32 m0, s56, 90112
    s_waitcnt lgkmcnt(6)
    v_mfma_f32_32x32x16_bf16 v[32:47], a[92:95], v[68:71], v[32:47]
    ds_read_b64_tr_b16 v[60:61], v4 offset:58368
    ds_read_b64_tr_b16 v[62:63], v4 offset:58624
    global_load_lds_dwordx4 v2, s[28:29] offset:0 sc1
    s_waitcnt lgkmcnt(6)
    v_mfma_f32_32x32x16_bf16 v[16:31], a[96:99], v[48:51], v[16:31]
    ds_read_b64_tr_b16 v[64:65], v4 offset:26624
    ds_read_b64_tr_b16 v[66:67], v4 offset:26880
    global_load_lds_dwordx4 v2, s[28:29] offset:1024 sc1
    s_waitcnt lgkmcnt(6)
    v_mfma_f32_32x32x16_bf16 v[32:47], a[96:99], v[52:55], v[32:47]
    ds_read_b64_tr_b16 v[68:69], v4 offset:59392
    ds_read_b64_tr_b16 v[70:71], v4 offset:59648
    global_load_lds_dwordx4 v2, s[28:29] offset:2048 sc1
    s_waitcnt lgkmcnt(6)
    v_mfma_f32_32x32x16_bf16 v[16:31], a[100:103], v[56:59], v[16:31]
    ds_read_b64_tr_b16 v[48:49], v4 offset:27648
    ds_read_b64_tr_b16 v[50:51], v4 offset:27904
    global_load_lds_dwordx4 v2, s[28:29] offset:3072 sc1
    s_waitcnt lgkmcnt(6)
    v_mfma_f32_32x32x16_bf16 v[32:47], a[100:103], v[60:63], v[32:47]
    ds_read_b64_tr_b16 v[52:53], v4 offset:60416
    ds_read_b64_tr_b16 v[54:55], v4 offset:60672
    global_load_dwordx2 v[8:9], v6, s[70:71] offset:0 sc1
    s_waitcnt lgkmcnt(6)
    v_mfma_f32_32x32x16_bf16 v[16:31], a[104:107], v[64:67], v[16:31]
    ds_read_b64_tr_b16 v[56:57], v4 offset:28672
    ds_read_b64_tr_b16 v[58:59], v4 offset:28928
    global_load_dwordx2 v[10:11], v6, s[70:71] offset:256 sc1
    s_waitcnt lgkmcnt(6)
    v_mfma_f32_32x32x16_bf16 v[32:47], a[104:107], v[68:71], v[32:47]
    ds_read_b64_tr_b16 v[60:61], v4 offset:61440
    ds_read_b64_tr_b16 v[62:63], v4 offset:61696
    s_waitcnt lgkmcnt(6)
    v_mfma_f32_32x32x16_bf16 v[16:31], a[108:111], v[48:51], v[16:31]
    ds_read_b64_tr_b16 v[64:65], v4 offset:29696
    ds_read_b64_tr_b16 v[66:67], v4 offset:29952
    global_load_dwordx4 a[224:227], v2, s[32:33] offset:0 sc1
    s_waitcnt lgkmcnt(6)
    v_mfma_f32_32x32x16_bf16 v[32:47], a[108:111], v[52:55], v[32:47]
    ds_read_b64_tr_b16 v[68:69], v4 offset:62464
    ds_read_b64_tr_b16 v[70:71], v4 offset:62720
    s_waitcnt lgkmcnt(6)
    v_mfma_f32_32x32x16_bf16 v[16:31], a[112:115], v[56:59], v[16:31]
    ds_read_b64_tr_b16 v[48:49], v4 offset:30720
    ds_read_b64_tr_b16 v[50:51], v4 offset:30976
    global_load_dwordx4 a[228:231], v113, s[32:33] offset:0 sc1
    s_waitcnt lgkmcnt(6)
    v_mfma_f32_32x32x16_bf16 v[32:47], a[112:115], v[60:63], v[32:47]
    ds_read_b64_tr_b16 v[52:53], v4 offset:63488
    ds_read_b64_tr_b16 v[54:55], v4 offset:63744
    s_waitcnt lgkmcnt(6)
    v_mfma_f32_32x32x16_bf16 v[16:31], a[116:119], v[64:67], v[16:31]
    ds_read_b64_tr_b16 v[56:57], v4 offset:31744
    ds_read_b64_tr_b16 v[58:59], v4 offset:32000
    global_load_dwordx4 a[232:235], v2, s[32:33] offset:1024 sc1
    s_waitcnt lgkmcnt(6)
    v_mfma_f32_32x32x16_bf16 v[32:47], a[116:119], v[68:71], v[32:47]
    ds_read_b64_tr_b16 v[60:61], v4 offset:64512
    ds_read_b64_tr_b16 v[62:63], v4 offset:64768
    s_waitcnt lgkmcnt(6)
    v_mfma_f32_32x32x16_bf16 v[16:31], a[120:123], v[48:51], v[16:31]
    global_load_dwordx4 a[236:239], v113, s[32:33] offset:1024 sc1
    s_waitcnt lgkmcnt(4)
    v_mfma_f32_32x32x16_bf16 v[32:47], a[120:123], v[52:55], v[32:47]
    s_waitcnt lgkmcnt(2)
    v_mfma_f32_32x32x16_bf16 v[16:31], a[124:127], v[56:59], v[16:31]
    global_load_dwordx4 a[240:243], v2, s[32:33] offset:2048 sc1
    s_waitcnt lgkmcnt(0)
    v_mfma_f32_32x32x16_bf16 v[32:47], a[124:127], v[60:63], v[32:47]
    s_waitcnt vmcnt(5)
    s_mov_b32 s80, 0
L_chk0_p:
    v_min_u32 v80, v9, v11
    v_cmp_eq_u32 vcc, 0, v80
    s_nop 0
    s_cbranch_vccz L_chk0_w
    s_add_u32 s80, s80, 1
    s_cmp_gt_u32 s80, 0x80000
    s_cbranch_scc1 L_chk0_w
    s_sleep 2
    global_load_dwordx2 v[8:9], v6, s[70:71] offset:0 sc1
    global_load_dwordx2 v[10:11], v6, s[70:71] offset:256 sc1
    s_waitcnt vmcnt(0)
    s_branch L_chk0_p
L_chk0_w:
    s_add_u32 s70, s70, 0x2000
    s_addc_u32 s71, s71, 0
    s_nop 7
    v_pk_fma_f32 v[16:17], v[128:129], v[8:9], v[16:17] op_sel_hi:[1,0,1] neg_lo:[0,1,0] neg_hi:[0,1,0]
    v_pk_fma_f32 v[18:19], v[130:131], v[8:9], v[18:19] op_sel_hi:[1,0,1] neg_lo:[0,1,0] neg_hi:[0,1,0]
    v_pk_fma_f32 v[20:21], v[132:133], v[8:9], v[20:21] op_sel_hi:[1,0,1] neg_lo:[0,1,0] neg_hi:[0,1,0]
    v_pk_fma_f32 v[22:23], v[134:135], v[8:9], v[22:23] op_sel_hi:[1,0,1] neg_lo:[0,1,0] neg_hi:[0,1,0]
    v_pk_fma_f32 v[24:25], v[136:137], v[8:9], v[24:25] op_sel_hi:[1,0,1] neg_lo:[0,1,0] neg_hi:[0,1,0]
    v_pk_fma_f32 v[26:27], v[138:139], v[8:9], v[26:27] op_sel_hi:[1,0,1] neg_lo:[0,1,0] neg_hi:[0,1,0]
    v_pk_fma_f32 v[28:29], v[140:141], v[8:9], v[28:29] op_sel_hi:[1,0,1] neg_lo:[0,1,0] neg_hi:[0,1,0]
    v_pk_fma_f32 v[30:31], v[142:143], v[8:9], v[30:31] op_sel_hi:[1,0,1] neg_lo:[0,1,0] neg_hi:[0,1,0]
    v_pk_fma_f32 v[16:17], v[8:9], v[16:17], v[144:145] op_sel:[1,0,0] op_sel_hi:[1,1,1]
    v_pk_fma_f32 v[18:19], v[8:9], v[18:19], v[146:147] op_sel:[1,0,0] op_sel_hi:[1,1,1]
    v_pk_fma_f32 v[20:21], v[8:9], v[20:21], v[148:149] op_sel:[1,0,0] op_sel_hi:[1,1,1]
    v_pk_fma_f32 v[22:23], v[8:9], v[22:23], v[150:151] op_sel:[1,0,0] op_sel_hi:[1,1,1]
    v_pk_fma_f32 v[24:25], v[8:9], v[24:25], v[152:153] op_sel:[1,0,0] op_sel_hi:[1,1,1]
    v_pk_fma_f32 v[26:27], v[8:9], v[26:27], v[154:155] op_sel:[1,0,0] op_sel_hi:[1,1,1]
    v_pk_fma_f32 v[28:29], v[8:9], v[28:29], v[156:157] op_sel:[1,0,0] op_sel_hi:[1,1,1]
    v_pk_fma_f32 v[30:31], v[8:9], v[30:31], v[158:159] op_sel:[1,0,0] op_sel_hi:[1,1,1]
    v_exp_f32 v80, v16
    v_exp_f32 v81, v17
    v_exp_f32 v82, v18
    v_exp_f32 v83, v19
    global_load_dwordx4 a[244:247], v113, s[32:33] offset:2048 sc1
    v_exp_f32 v84, v20
    v_exp_f32 v85, v21
    v_exp_f32 v86, v22
    v_exp_f32 v87, v23
    global_load_dwordx4 a[248:251], v2, s[32:33] offset:3072 sc1
    v_exp_f32 v88, v24
    v_exp_f32 v89, v25
    v_exp_f32 v90, v26
    v_exp_f32 v91, v27
    global_load_dwordx4 a[252:255], v113, s[32:33] offset:3072 sc1
    v_exp_f32 v92, v28
    v_exp_f32 v93, v29
    v_exp_f32_e64 v94, v30
    v_exp_f32 v95, v31
    s_add_u32 s32, s32, 4096
    s_addc_u32 s33, s33, 0
    v_pk_add_f32 v[80:81], v[80:81], 1.0 op_sel_hi:[1,0]
    v_pk_add_f32 v[82:83], v[82:83], 1.0 op_sel_hi:[1,0]
    v_pk_add_f32 v[84:85], v[84:85], 1.0 op_sel_hi:[1,0]
    v_pk_add_f32 v[86:87], v[86:87], 1.0 op_sel_hi:[1,0]
    v_pk_add_f32 v[88:89], v[88:89], 1.0 op_sel_hi:[1,0]
    v_pk_add_f32 v[90:91], v[90:91], 1.0 op_sel_hi:[1,0]
    v_pk_add_f32 v[92:93], v[92:93], 1.0 op_sel_hi:[1,0]
    v_pk_add_f32 v[94:95], v[94:95], 1.0 op_sel_hi:[1,0]
    v_rcp_f32 v80, v80
    v_rcp_f32 v81, v81
    v_rcp_f32 v82, v82
    v_rcp_f32 v83, v83
    global_load_dwordx4 v[160:163], v2, s[32:33] offset:0 sc1
    v_rcp_f32 v84, v84
    v_rcp_f32 v85, v85
    v_rcp_f32 v86, v86
    v_rcp_f32 v87, v87
    global_load_dwordx4 v[164:167], v113, s[32:33] offset:0 sc1
    v_rcp_f32 v88, v88
    v_rcp_f32 v89, v89
    v_rcp_f32 v90, v90
    v_rcp_f32 v91, v91
    global_load_dwordx4 v[168:171], v2, s[32:33] offset:1024 sc1
    v_rcp_f32 v92, v92
    v_rcp_f32 v93, v93
    v_rcp_f32 v94, v94
    v_rcp_f32 v95, v95
    global_load_dwordx4 v[172:175], v113, s[32:33] offset:1024 sc1
    v_pk_mul_f32 v[16:17], v[16:17], v[80:81]
    v_pk_mul_f32 v[18:19], v[18:19], v[82:83]
    v_pk_mul_f32 v[20:21], v[20:21], v[84:85]
    v_pk_mul_f32 v[22:23], v[22:23], v[86:87]
    v_pk_mul_f32 v[24:25], v[24:25], v[88:89]
    v_pk_mul_f32 v[26:27], v[26:27], v[90:91]
    v_pk_mul_f32 v[28:29], v[28:29], v[92:93]
    v_pk_mul_f32 v[30:31], v[30:31], v[94:95]
    v_cvt_pk_bf16_f32 v96, v16, v17
    v_cvt_pk_bf16_f32 v97, v18, v19
    v_cvt_pk_bf16_f32 v98, v20, v21
    v_cvt_pk_bf16_f32 v99, v22, v23
    v_cvt_pk_bf16_f32 v100, v24, v25
    v_cvt_pk_bf16_f32 v101, v26, v27
    v_cvt_pk_bf16_f32 v102, v28, v29
    v_cvt_pk_bf16_f32 v103, v30, v31
    global_store_dwordx4 v2, v[96:99], s[68:69] sc1
    global_store_dwordx4 v2, v[100:103], s[68:69] offset:1024 sc1
    v_pk_fma_f32 v[32:33], v[128:129], v[10:11], v[32:33] op_sel_hi:[1,0,1] neg_lo:[0,1,0] neg_hi:[0,1,0]
    v_pk_fma_f32 v[34:35], v[130:131], v[10:11], v[34:35] op_sel_hi:[1,0,1] neg_lo:[0,1,0] neg_hi:[0,1,0]
    v_pk_fma_f32 v[36:37], v[132:133], v[10:11], v[36:37] op_sel_hi:[1,0,1] neg_lo:[0,1,0] neg_hi:[0,1,0]
    v_pk_fma_f32 v[38:39], v[134:135], v[10:11], v[38:39] op_sel_hi:[1,0,1] neg_lo:[0,1,0] neg_hi:[0,1,0]
    v_pk_fma_f32 v[40:41], v[136:137], v[10:11], v[40:41] op_sel_hi:[1,0,1] neg_lo:[0,1,0] neg_hi:[0,1,0]
    v_pk_fma_f32 v[42:43], v[138:139], v[10:11], v[42:43] op_sel_hi:[1,0,1] neg_lo:[0,1,0] neg_hi:[0,1,0]
    v_pk_fma_f32 v[44:45], v[140:141], v[10:11], v[44:45] op_sel_hi:[1,0,1] neg_lo:[0,1,0] neg_hi:[0,1,0]
    v_pk_fma_f32 v[46:47], v[142:143], v[10:11], v[46:47] op_sel_hi:[1,0,1] neg_lo:[0,1,0] neg_hi:[0,1,0]
    v_pk_fma_f32 v[32:33], v[10:11], v[32:33], v[144:145] op_sel:[1,0,0] op_sel_hi:[1,1,1]
    v_pk_fma_f32 v[34:35], v[10:11], v[34:35], v[146:147] op_sel:[1,0,0] op_sel_hi:[1,1,1]
    v_pk_fma_f32 v[36:37], v[10:11], v[36:37], v[148:149] op_sel:[1,0,0] op_sel_hi:[1,1,1]
    v_pk_fma_f32 v[38:39], v[10:11], v[38:39], v[150:151] op_sel:[1,0,0] op_sel_hi:[1,1,1]
    v_pk_fma_f32 v[40:41], v[10:11], v[40:41], v[152:153] op_sel:[1,0,0] op_sel_hi:[1,1,1]
    v_pk_fma_f32 v[42:43], v[10:11], v[42:43], v[154:155] op_sel:[1,0,0] op_sel_hi:[1,1,1]
    v_pk_fma_f32 v[44:45], v[10:11], v[44:45], v[156:157] op_sel:[1,0,0] op_sel_hi:[1,1,1]
    v_pk_fma_f32 v[46:47], v[10:11], v[46:47], v[158:159] op_sel:[1,0,0] op_sel_hi:[1,1,1]
    v_exp_f32 v80, v32
    v_exp_f32 v81, v33
    v_exp_f32 v82, v34
    v_exp_f32 v83, v35
    v_exp_f32 v84, v36
    v_exp_f32 v85, v37
    v_exp_f32 v86, v38
    v_exp_f32 v87, v39
    v_exp_f32 v88, v40
    v_exp_f32 v89, v41
    v_exp_f32 v90, v42
    v_exp_f32 v91, v43
    v_exp_f32 v92, v44
    v_exp_f32 v93, v45
    v_exp_f32 v94, v46
    v_exp_f32 v95, v47
    v_pk_add_f32 v[80:81], v[80:81], 1.0 op_sel_hi:[1,0]
    v_pk_add_f32 v[82:83], v[82:83], 1.0 op_sel_hi:[1,0]
    v_pk_add_f32 v[84:85], v[84:85], 1.0 op_sel_hi:[1,0]
    v_pk_add_f32 v[86:87], v[86:87], 1.0 op_sel_hi:[1,0]
    v_pk_add_f32 v[88:89], v[88:89], 1.0 op_sel_hi:[1,0]
    v_pk_add_f32 v[90:91], v[90:91], 1.0 op_sel_hi:[1,0]
    v_pk_add_f32 v[92:93], v[92:93], 1.0 op_sel_hi:[1,0]
    v_pk_add_f32 v[94:95], v[94:95], 1.0 op_sel_hi:[1,0]
    v_rcp_f32 v80, v80
    v_rcp_f32 v81, v81
    v_rcp_f32 v82, v82
    v_rcp_f32 v83, v83
    v_rcp_f32 v84, v84
    v_rcp_f32 v85, v85
    v_rcp_f32 v86, v86
    v_rcp_f32 v87, v87
    v_rcp_f32 v88, v88
    v_rcp_f32 v89, v89
    v_rcp_f32 v90, v90
    v_rcp_f32 v91, v91
    v_rcp_f32 v92, v92
    v_rcp_f32 v93, v93
    v_rcp_f32 v94, v94
    v_rcp_f32 v95, v95
    v_pk_mul_f32 v[32:33], v[32:33], v[80:81]
    v_pk_mul_f32 v[34:35], v[34:35], v[82:83]
    v_pk_mul_f32 v[36:37], v[36:37], v[84:85]
    v_pk_mul_f32 v[38:39], v[38:39], v[86:87]
    v_pk_mul_f32 v[40:41], v[40:41], v[88:89]
    v_pk_mul_f32 v[42:43], v[42:43], v[90:91]
    v_pk_mul_f32 v[44:45], v[44:45], v[92:93]
    v_pk_mul_f32 v[46:47], v[46:47], v[94:95]
    v_cvt_pk_bf16_f32 v104, v32, v33
    v_cvt_pk_bf16_f32 v105, v34, v35
    v_cvt_pk_bf16_f32 v106, v36, v37
    v_cvt_pk_bf16_f32 v107, v38, v39
    v_cvt_pk_bf16_f32 v108, v40, v41
    v_cvt_pk_bf16_f32 v109, v42, v43
    v_cvt_pk_bf16_f32 v110, v44, v45
    v_cvt_pk_bf16_f32 v111, v46, v47
    global_store_dwordx4 v113, v[104:107], s[68:69] sc1
    global_store_dwordx4 v113, v[108:111], s[68:69] offset:1024 sc1
    s_add_u32 s68, s68, 3670016
    s_addc_u32 s69, s69, 0
    s_barrier
    ds_read_b64_tr_b16 v[48:49], v5 offset:0
    ds_read_b64_tr_b16 v[50:51], v5 offset:256
    ds_read_b64_tr_b16 v[52:53], v5 offset:32768
    ds_read_b64_tr_b16 v[54:55], v5 offset:33024
    ds_read_b64_tr_b16 v[56:57], v5 offset:1024
    ds_read_b64_tr_b16 v[58:59], v5 offset:1280
    ds_read_b64_tr_b16 v[60:61], v5 offset:33792
    ds_read_b64_tr_b16 v[62:63], v5 offset:34048
    s_nop 0
    s_waitcnt lgkmcnt(6)
    v_mfma_f32_32x32x16_bf16 v[16:31], a[0:3], v[48:51], 0
    ds_read_b64_tr_b16 v[64:65], v5 offset:2048
    ds_read_b64_tr_b16 v[66:67], v5 offset:2304
    global_load_dwordx4 v[176:179], v2, s[32:33] offset:2048 sc1
    s_waitcnt lgkmcnt(6)
    v_mfma_f32_32x32x16_bf16 v[32:47], a[0:3], v[52:55], 0
    ds_read_b64_tr_b16 v[68:69], v5 offset:34816
    ds_read_b64_tr_b16 v[70:71], v5 offset:35072
    s_waitcnt lgkmcnt(6)
    v_mfma_f32_32x32x16_bf16 v[16:31], a[4:7], v[56:59], v[16:31]
    ds_read_b64_tr_b16 v[48:49], v5 offset:3072
    ds_read_b64_tr_b16 v[50:51], v5 offset:3328
    global_load_dwordx4 v[180:183], v113, s[32:33] offset:2048 sc1
    s_waitcnt lgkmcnt(6)
    v_mfma_f32_32x32x16_bf16 v[32:47], a[4:7], v[60:63], v[32:47]
    ds_read_b64_tr_b16 v[52:53], v5 offset:35840
    ds_read_b64_tr_b16 v[54:55], v5 offset:36096
    s_waitcnt lgkmcnt(6)
    v_mfma_f32_32x32x16_bf16 v[16:31], a[8:11], v[64:67], v[16:31]
    ds_read_b64_tr_b16 v[56:57], v5 offset:4096
    ds_read_b64_tr_b16 v[58:59], v5 offset:4352
    global_load_dwordx4 v[184:187], v2, s[32:33] offset:3072 sc1
    s_waitcnt lgkmcnt(6)
    v_mfma_f32_32x32x16_bf16 v[32:47], a[8:11], v[68:71], v[32:47]
    ds_read_b64_tr_b16 v[60:61], v5 offset:36864
    ds_read_b64_tr_b16 v[62:63], v5 offset:37120
    s_waitcnt lgkmcnt(6)
    v_mfma_f32_32x32x16_bf16 v[16:31], a[12:15], v[48:51], v[16:31]
    ds_read_b64_tr_b16 v[64:65], v5 offset:5120
    ds_read_b64_tr_b16 v[66:67], v5 offset:5376
    global_load_dwordx4 v[188:191], v113, s[32:33] offset:3072 sc1
    s_waitcnt lgkmcnt(6)
    v_mfma_f32_32x32x16_bf16 v[32:47], a[12:15], v[52:55], v[32:47]
    ds_read_b64_tr_b16 v[68:69], v5 offset:37888
    ds_read_b64_tr_b16 v[70:71], v5 offset:38144
    s_waitcnt lgkmcnt(6)
    v_mfma_f32_32x32x16_bf16 v[16:31], a[16:19], v[56:59], v[16:31]
    ds_read_b64_tr_b16 v[48:49], v5 offset:6144
    ds_read_b64_tr_b16 v[50:51], v5 offset:6400
    s_add_u32 s32, s32, 4096
    s_addc_u32 s33, s33, 0
    s_waitcnt lgkmcnt(6)
    v_mfma_f32_32x32x16_bf16 v[32:47], a[16:19], v[60:63], v[32:47]
    ds_read_b64_tr_b16 v[52:53], v5 offset:38912
    ds_read_b64_tr_b16 v[54:55], v5 offset:39168
    s_waitcnt lgkmcnt(6)
    v_mfma_f32_32x32x16_bf16 v[16:31], a[20:23], v[64:67], v[16:31]
    ds_read_b64_tr_b16 v[56:57], v5 offset:7168
    ds_read_b64_tr_b16 v[58:59], v5 offset:7424
    global_load_dwordx4 v[192:195], v2, s[32:33] offset:0 sc1
    s_waitcnt lgkmcnt(6)
    v_mfma_f32_32x32x16_bf16 v[32:47], a[20:23], v[68:71], v[32:47]
    ds_read_b64_tr_b16 v[60:61], v5 offset:39936
    ds_read_b64_tr_b16 v[62:63], v5 offset:40192
    s_barrier
    s_waitcnt lgkmcnt(6)
    v_mfma_f32_32x32x16_bf16 v[16:31], a[24:27], v[48:51], v[16:31]
    ds_read_b64_tr_b16 v[64:65], v5 offset:8192
    ds_read_b64_tr_b16 v[66:67], v5 offset:8448
    global_load_dwordx4 v[196:199], v113, s[32:33] offset:0 sc1
    s_waitcnt lgkmcnt(6)
    v_mfma_f32_32x32x16_bf16 v[32:47], a[24:27], v[52:55], v[32:47]
    ds_read_b64_tr_b16 v[68:69], v5 offset:40960
    ds_read_b64_tr_b16 v[70:71], v5 offset:41216
    s_waitcnt lgkmcnt(6)
    v_mfma_f32_32x32x16_bf16 v[16:31], a[28:31], v[56:59], v[16:31]
    ds_read_b64_tr_b16 v[48:49], v5 offset:9216
    ds_read_b64_tr_b16 v[50:51], v5 offset:9472
    global_load_dwordx4 v[200:203], v2, s[32:33] offset:1024 sc1
    s_waitcnt lgkmcnt(6)
    v_mfma_f32_32x32x16_bf16 v[32:47], a[28:31], v[60:63], v[32:47]
    ds_read_b64_tr_b16 v[52:53], v5 offset:41984
    ds_read_b64_tr_b16 v[54:55], v5 offset:42240
    s_waitcnt lgkmcnt(6)
    v_mfma_f32_32x32x16_bf16 v[16:31], a[32:35], v[64:67], v[16:31]
    ds_read_b64_tr_b16 v[56:57], v5 offset:10240
    ds_read_b64_tr_b16 v[58:59], v5 offset:10496
    global_load_dwordx4 v[204:207], v113, s[32:33] offset:1024 sc1
    s_waitcnt lgkmcnt(6)
    v_mfma_f32_32x32x16_bf16 v[32:47], a[32:35], v[68:71], v[32:47]
    ds_read_b64_tr_b16 v[60:61], v5 offset:43008
    ds_read_b64_tr_b16 v[62:63], v5 offset:43264
    s_waitcnt lgkmcnt(6)
    v_mfma_f32_32x32x16_bf16 v[16:31], a[36:39], v[48:51], v[16:31]
    ds_read_b64_tr_b16 v[64:65], v5 offset:11264
    ds_read_b64_tr_b16 v[66:67], v5 offset:11520
    global_load_dwordx4 v[208:211], v2, s[32:33] offset:2048 sc1
    s_waitcnt lgkmcnt(6)
    v_mfma_f32_32x32x16_bf16 v[32:47], a[36:39], v[52:55], v[32:47]
    ds_read_b64_tr_b16 v[68:69], v5 offset:44032
    ds_read_b64_tr_b16 v[70:71], v5 offset:44288
    s_waitcnt lgkmcnt(6)
    v_mfma_f32_32x32x16_bf16 v[16:31], a[40:43], v[56:59], v[16:31]
    ds_read_b64_tr_b16 v[48:49], v5 offset:12288
    ds_read_b64_tr_b16 v[50:51], v5 offset:12544
    global_load_dwordx4 v[212:215], v113, s[32:33] offset:2048 sc1
    s_waitcnt lgkmcnt(6)
    v_mfma_f32_32x32x16_bf16 v[32:47], a[40:43], v[60:63], v[32:47]
    ds_read_b64_tr_b16 v[52:53], v5 offset:45056
    ds_read_b64_tr_b16 v[54:55], v5 offset:45312
    s_waitcnt lgkmcnt(6)
    v_mfma_f32_32x32x16_bf16 v[16:31], a[44:47], v[64:67], v[16:31]
    ds_read_b64_tr_b16 v[56:57], v5 offset:13312
    ds_read_b64_tr_b16 v[58:59], v5 offset:13568
    global_load_dwordx4 v[216:219], v2, s[32:33] offset:3072 sc1
    s_waitcnt lgkmcnt(6)
    v_mfma_f32_32x32x16_bf16 v[32:47], a[44:47], v[68:71], v[32:47]
    ds_read_b64_tr_b16 v[60:61], v5 offset:46080
    ds_read_b64_tr_b16 v[62:63], v5 offset:46336
    s_waitcnt lgkmcnt(6)
    v_mfma_f32_32x32x16_bf16 v[16:31], a[48:51], v[48:51], v[16:31]
    ds_read_b64_tr_b16 v[64:65], v5 offset:14336
    ds_read_b64_tr_b16 v[66:67], v5 offset:14592
    global_load_dwordx4 v[220:223], v113, s[32:33] offset:3072 sc1
    s_waitcnt lgkmcnt(6)
    v_mfma_f32_32x32x16_bf16 v[32:47], a[48:51], v[52:55], v[32:47]
    ds_read_b64_tr_b16 v[68:69], v5 offset:47104
    ds_read_b64_tr_b16 v[70:71], v5 offset:47360
    s_waitcnt lgkmcnt(6)
    v_mfma_f32_32x32x16_bf16 v[16:31], a[52:55], v[56:59], v[16:31]
    ds_read_b64_tr_b16 v[48:49], v5 offset:15360
    ds_read_b64_tr_b16 v[50:51], v5 offset:15616
    s_add_u32 s32, s32, 4096
    s_addc_u32 s33, s33, 0
    s_waitcnt lgkmcnt(6)
    v_mfma_f32_32x32x16_bf16 v[32:47], a[52:55], v[60:63], v[32:47]
    ds_read_b64_tr_b16 v[52:53], v5 offset:48128
    ds_read_b64_tr_b16 v[54:55], v5 offset:48384
    s_waitcnt vmcnt(12)
    s_barrier
    s_cmp_lg_u32 s50, 1
    s_cbranch_scc1 L_f3a_s
    s_add_u32 s80, s10, 0xc000
    v_lshl_add_u32 v73, v1, 10, s80
    v_mov_b32 v74, s81
    s_mov_b64 exec, 1
    global_store_dword v73, v74, s[14:15] sc1
    s_mov_b64 exec, -1
L_f3a_s:
    s_waitcnt lgkmcnt(6)
    v_mfma_f32_32x32x16_bf16 v[16:31], a[56:59], v[64:67], v[16:31]
    ds_read_b64_tr_b16 v[56:57], v5 offset:16384
    ds_read_b64_tr_b16 v[58:59], v5 offset:16640
    global_load_dwordx4 v[224:227], v2, s[32:33] offset:0 sc1
    s_waitcnt lgkmcnt(6)
    v_mfma_f32_32x32x16_bf16 v[32:47], a[56:59], v[68:71], v[32:47]
    ds_read_b64_tr_b16 v[60:61], v5 offset:49152
    ds_read_b64_tr_b16 v[62:63], v5 offset:49408
    s_waitcnt lgkmcnt(6)
    v_mfma_f32_32x32x16_bf16 v[16:31], a[60:63], v[48:51], v[16:31]
    ds_read_b64_tr_b16 v[64:65], v5 offset:17408
    ds_read_b64_tr_b16 v[66:67], v5 offset:17664
    global_load_dwordx4 v[228:231], v113, s[32:33] offset:0 sc1
    s_waitcnt lgkmcnt(6)
    v_mfma_f32_32x32x16_bf16 v[32:47], a[60:63], v[52:55], v[32:47]
    ds_read_b64_tr_b16 v[68:69], v5 offset:50176
    ds_read_b64_tr_b16 v[70:71], v5 offset:50432
    s_waitcnt lgkmcnt(6)
    v_mfma_f32_32x32x16_bf16 v[16:31], a[64:67], v[56:59], v[16:31]
    ds_read_b64_tr_b16 v[48:49], v5 offset:18432
    ds_read_b64_tr_b16 v[50:51], v5 offset:18688
    global_load_dwordx4 v[232:235], v2, s[32:33] offset:1024 sc1
    s_waitcnt lgkmcnt(6)
    v_mfma_f32_32x32x16_bf16 v[32:47], a[64:67], v[60:63], v[32:47]
    ds_read_b64_tr_b16 v[52:53], v5 offset:51200
    ds_read_b64_tr_b16 v[54:55], v5 offset:51456
    s_waitcnt lgkmcnt(6)
    v_mfma_f32_32x32x16_bf16 v[16:31], a[68:71], v[64:67], v[16:31]
    ds_read_b64_tr_b16 v[56:57], v5 offset:19456
    ds_read_b64_tr_b16 v[58:59], v5 offset:19712
    global_load_dwordx4 v[236:239], v113, s[32:33] offset:1024 sc1
    s_waitcnt lgkmcnt(6)
    v_mfma_f32_32x32x16_bf16 v[32:47], a[68:71], v[68:71], v[32:47]
    ds_read_b64_tr_b16 v[60:61], v5 offset:52224
    ds_read_b64_tr_b16 v[62:63], v5 offset:52480
    s_waitcnt lgkmcnt(6)
    v_mfma_f32_32x32x16_bf16 v[16:31], a[72:75], v[48:51], v[16:31]
    ds_read_b64_tr_b16 v[64:65], v5 offset:20480
    ds_read_b64_tr_b16 v[66:67], v5 offset:20736
    global_load_dwordx4 v[240:243], v2, s[32:33] offset:2048 sc1
    s_waitcnt lgkmcnt(6)
    v_mfma_f32_32x32x16_bf16 v[32:47], a[72:75], v[52:55], v[32:47]
    ds_read_b64_tr_b16 v[68:69], v5 offset:53248
    ds_read_b64_tr_b16 v[70:71], v5 offset:53504
    s_waitcnt lgkmcnt(6)
    v_mfma_f32_32x32x16_bf16 v[16:31], a[76:79], v[56:59], v[16:31]
    ds_read_b64_tr_b16 v[48:49], v5 offset:21504
    ds_read_b64_tr_b16 v[50:51], v5 offset:21760
    global_load_dwordx4 v[244:247], v113, s[32:33] offset:2048 sc1
    s_waitcnt lgkmcnt(6)
    v_mfma_f32_32x32x16_bf16 v[32:47], a[76:79], v[60:63], v[32:47]
    ds_read_b64_tr_b16 v[52:53], v5 offset:54272
    ds_read_b64_tr_b16 v[54:55], v5 offset:54528
    s_waitcnt lgkmcnt(6)
    v_mfma_f32_32x32x16_bf16 v[16:31], a[80:83], v[64:67], v[16:31]
    ds_read_b64_tr_b16 v[56:57], v5 offset:22528
    ds_read_b64_tr_b16 v[58:59], v5 offset:22784
    global_load_dwordx4 v[248:251], v2, s[32:33] offset:3072 sc1
    s_waitcnt lgkmcnt(6)
    v_mfma_f32_32x32x16_bf16 v[32:47], a[80:83], v[68:71], v[32:47]
    ds_read_b64_tr_b16 v[60:61], v5 offset:55296
    ds_read_b64_tr_b16 v[62:63], v5 offset:55552
    s_waitcnt lgkmcnt(6)
    v_mfma_f32_32x32x16_bf16 v[16:31], a[84:87], v[48:51], v[16:31]
    ds_read_b64_tr_b16 v[64:65], v5 offset:23552
    ds_read_b64_tr_b16 v[66:67], v5 offset:23808
    global_load_dwordx4 v[252:255], v113, s[32:33] offset:3072 sc1
    s_waitcnt lgkmcnt(6)
    v_mfma_f32_32x32x16_bf16 v[32:47], a[84:87], v[52:55], v[32:47]
    ds_read_b64_tr_b16 v[68:69], v5 offset:56320
    ds_read_b64_tr_b16 v[70:71], v5 offset:56576
    s_barrier
    s_waitcnt lgkmcnt(6)
    v_mfma_f32_32x32x16_bf16 v[16:31], a[88:91], v[56:59], v[16:31]
    ds_read_b64_tr_b16 v[48:49], v5 offset:24576
    ds_read_b64_tr_b16 v[50:51], v5 offset:24832
    global_load_dwordx2 v[8:9], v6, s[70:71] offset:0 sc1
    s_waitcnt lgkmcnt(6)
    v_mfma_f32_32x32x16_bf16 v[32:47], a[88:91], v[60:63], v[32:47]
    ds_read_b64_tr_b16 v[52:53], v5 offset:57344
    ds_read_b64_tr_b16 v[54:55], v5 offset:57600
    global_load_dwordx2 v[10:11], v6, s[70:71] offset:256 sc1
    s_waitcnt lgkmcnt(6)
    v_mfma_f32_32x32x16_bf16 v[16:31], a[92:95], v[64:67], v[16:31]
    ds_read_b64_tr_b16 v[56:57], v5 offset:25600
    ds_read_b64_tr_b16 v[58:59], v5 offset:25856
    s_waitcnt lgkmcnt(6)
    v_mfma_f32_32x32x16_bf16 v[32:47], a[92:95], v[68:71], v[32:47]
    ds_read_b64_tr_b16 v[60:61], v5 offset:58368
    ds_read_b64_tr_b16 v[62:63], v5 offset:58624
    s_waitcnt lgkmcnt(6)
    v_mfma_f32_32x32x16_bf16 v[16:31], a[96:99], v[48:51], v[16:31]
    ds_read_b64_tr_b16 v[64:65], v5 offset:26624
    ds_read_b64_tr_b16 v[66:67], v5 offset:26880
    s_waitcnt lgkmcnt(6)
    v_mfma_f32_32x32x16_bf16 v[32:47], a[96:99], v[52:55], v[32:47]
    ds_read_b64_tr_b16 v[68:69], v5 offset:59392
    ds_read_b64_tr_b16 v[70:71], v5 offset:59648
    s_waitcnt lgkmcnt(6)
    v_mfma_f32_32x32x16_bf16 v[16:31], a[100:103], v[56:59], v[16:31]
    ds_read_b64_tr_b16 v[48:49], v5 offset:27648
    ds_read_b64_tr_b16 v[50:51], v5 offset:27904
    s_waitcnt lgkmcnt(6)
    v_mfma_f32_32x32x16_bf16 v[32:47], a[100:103], v[60:63], v[32:47]
    ds_read_b64_tr_b16 v[52:53], v5 offset:60416
    ds_read_b64_tr_b16 v[54:55], v5 offset:60672
    s_waitcnt lgkmcnt(6)
    v_mfma_f32_32x32x16_bf16 v[16:31], a[104:107], v[64:67], v[16:31]
    ds_read_b64_tr_b16 v[56:57], v5 offset:28672
    ds_read_b64_tr_b16 v[58:59], v5 offset:28928
    s_waitcnt lgkmcnt(6)
    v_mfma_f32_32x32x16_bf16 v[32:47], a[104:107], v[68:71], v[32:47]
    ds_read_b64_tr_b16 v[60:61], v5 offset:61440
    ds_read_b64_tr_b16 v[62:63], v5 offset:61696
    s_waitcnt lgkmcnt(6)
    v_mfma_f32_32x32x16_bf16 v[16:31], a[108:111], v[48:51], v[16:31]
    ds_read_b64_tr_b16 v[64:65], v5 offset:29696
    ds_read_b64_tr_b16 v[66:67], v5 offset:29952
    s_waitcnt lgkmcnt(6)
    v_mfma_f32_32x32x16_bf16 v[32:47], a[108:111], v[52:55], v[32:47]
    ds_read_b64_tr_b16 v[68:69], v5 offset:62464
    ds_read_b64_tr_b16 v[70:71], v5 offset:62720
    s_waitcnt lgkmcnt(6)
    v_mfma_f32_32x32x16_bf16 v[16:31], a[112:115], v[56:59], v[16:31]
    ds_read_b64_tr_b16 v[48:49], v5 offset:30720
    ds_read_b64_tr_b16 v[50:51], v5 offset:30976
    s_waitcnt lgkmcnt(6)
    v_mfma_f32_32x32x16_bf16 v[32:47], a[112:115], v[60:63], v[32:47]
    ds_read_b64_tr_b16 v[52:53], v5 offset:63488
    ds_read_b64_tr_b16 v[54:55], v5 offset:63744
    s_waitcnt lgkmcnt(6)
    v_mfma_f32_32x32x16_bf16 v[16:31], a[116:119], v[64:67], v[16:31]
    ds_read_b64_tr_b16 v[56:57], v5 offset:31744
    ds_read_b64_tr_b16 v[58:59], v5 offset:32000
    s_waitcnt lgkmcnt(6)
    v_mfma_f32_32x32x16_bf16 v[32:47], a[116:119], v[68:71], v[32:47]
    ds_read_b64_tr_b16 v[60:61], v5 offset:64512
    ds_read_b64_tr_b16 v[62:63], v5 offset:64768
    s_waitcnt lgkmcnt(6)
    v_mfma_f32_32x32x16_bf16 v[16:31], a[120:123], v[48:51], v[16:31]
    s_waitcnt lgkmcnt(4)
    v_mfma_f32_32x32x16_bf16 v[32:47], a[120:123], v[52:55], v[32:47]
    s_waitcnt lgkmcnt(2)
    v_mfma_f32_32x32x16_bf16 v[16:31], a[124:127], v[56:59], v[16:31]
    s_waitcnt lgkmcnt(0)
    v_mfma_f32_32x32x16_bf16 v[32:47], a[124:127], v[60:63], v[32:47]
    s_waitcnt vmcnt(0)
    s_mov_b32 s80, 0
L_chk1_p:
    v_min_u32 v80, v9, v11
    v_cmp_eq_u32 vcc, 0, v80
    s_nop 0
    s_cbranch_vccz L_chk1_w
    s_add_u32 s80, s80, 1
    s_cmp_gt_u32 s80, 0x80000
    s_cbranch_scc1 L_chk1_w
    s_sleep 2
    global_load_dwordx2 v[8:9], v6, s[70:71] offset:0 sc1
    global_load_dwordx2 v[10:11], v6, s[70:71] offset:256 sc1
    s_waitcnt vmcnt(0)
    s_branch L_chk1_p
L_chk1_w:
    s_nop 7
    v_pk_fma_f32 v[16:17], v[128:129], v[8:9], v[16:17] op_sel_hi:[1,0,1] neg_lo:[0,1,0] neg_hi:[0,1,0]
    v_pk_fma_f32 v[18:19], v[130:131], v[8:9], v[18:19] op_sel_hi:[1,0,1] neg_lo:[0,1,0] neg_hi:[0,1,0]
    v_pk_fma_f32 v[20:21], v[132:133], v[8:9], v[20:21] op_sel_hi:[1,0,1] neg_lo:[0,1,0] neg_hi:[0,1,0]
    v_pk_fma_f32 v[22:23], v[134:135], v[8:9], v[22:23] op_sel_hi:[1,0,1] neg_lo:[0,1,0] neg_hi:[0,1,0]
    v_pk_fma_f32 v[24:25], v[136:137], v[8:9], v[24:25] op_sel_hi:[1,0,1] neg_lo:[0,1,0] neg_hi:[0,1,0]
    v_pk_fma_f32 v[26:27], v[138:139], v[8:9], v[26:27] op_sel_hi:[1,0,1] neg_lo:[0,1,0] neg_hi:[0,1,0]
    v_pk_fma_f32 v[28:29], v[140:141], v[8:9], v[28:29] op_sel_hi:[1,0,1] neg_lo:[0,1,0] neg_hi:[0,1,0]
    v_pk_fma_f32 v[30:31], v[142:143], v[8:9], v[30:31] op_sel_hi:[1,0,1] neg_lo:[0,1,0] neg_hi:[0,1,0]
    v_pk_fma_f32 v[16:17], v[8:9], v[16:17], v[144:145] op_sel:[1,0,0] op_sel_hi:[1,1,1]
    v_pk_fma_f32 v[18:19], v[8:9], v[18:19], v[146:147] op_sel:[1,0,0] op_sel_hi:[1,1,1]
    v_pk_fma_f32 v[20:21], v[8:9], v[20:21], v[148:149] op_sel:[1,0,0] op_sel_hi:[1,1,1]
    v_pk_fma_f32 v[22:23], v[8:9], v[22:23], v[150:151] op_sel:[1,0,0] op_sel_hi:[1,1,1]
    v_pk_fma_f32 v[24:25], v[8:9], v[24:25], v[152:153] op_sel:[1,0,0] op_sel_hi:[1,1,1]
    v_pk_fma_f32 v[26:27], v[8:9], v[26:27], v[154:155] op_sel:[1,0,0] op_sel_hi:[1,1,1]
    v_pk_fma_f32 v[28:29], v[8:9], v[28:29], v[156:157] op_sel:[1,0,0] op_sel_hi:[1,1,1]
    v_pk_fma_f32 v[30:31], v[8:9], v[30:31], v[158:159] op_sel:[1,0,0] op_sel_hi:[1,1,1]
    s_cmp_lg_u32 s50, 1
    s_cbranch_scc1 L_f3a_i
    global_load_dword v72, v122, s[14:15] offset:0 sc1
L_f3a_i:
    v_exp_f32 v80, v16
    v_exp_f32 v81, v17
    v_exp_f32 v82, v18
    v_exp_f32 v83, v19
    v_exp_f32 v84, v20
    v_exp_f32 v85, v21
    v_exp_f32 v86, v22
    v_exp_f32 v87, v23
    v_exp_f32 v88, v24
    v_exp_f32 v89, v25
    v_exp_f32 v90, v26
    v_exp_f32 v91, v27
    v_exp_f32 v92, v28
    v_exp_f32 v93, v29
    v_exp_f32 v94, v30
    v_exp_f32 v95, v31
    v_pk_add_f32 v[80:81], v[80:81], 1.0 op_sel_hi:[1,0]
    v_pk_add_f32 v[82:83], v[82:83], 1.0 op_sel_hi:[1,0]
    v_pk_add_f32 v[84:85], v[84:85], 1.0 op_sel_hi:[1,0]
    v_pk_add_f32 v[86:87], v[86:87], 1.0 op_sel_hi:[1,0]
    v_pk_add_f32 v[88:89], v[88:89], 1.0 op_sel_hi:[1,0]
    v_pk_add_f32 v[90:91], v[90:91], 1.0 op_sel_hi:[1,0]
    v_pk_add_f32 v[92:93], v[92:93], 1.0 op_sel_hi:[1,0]
    v_pk_add_f32 v[94:95], v[94:95], 1.0 op_sel_hi:[1,0]
    v_rcp_f32 v80, v80
    v_rcp_f32 v81, v81
    v_rcp_f32 v82, v82
    v_rcp_f32 v83, v83
    v_rcp_f32 v84, v84
    v_rcp_f32 v85, v85
    v_rcp_f32 v86, v86
    v_rcp_f32 v87, v87
    v_rcp_f32 v88, v88
    v_rcp_f32 v89, v89
    v_rcp_f32 v90, v90
    v_rcp_f32 v91, v91
    v_rcp_f32 v92, v92
    v_rcp_f32 v93, v93
    v_rcp_f32 v94, v94
    v_rcp_f32 v95, v95
    v_pk_mul_f32 v[16:17], v[16:17], v[80:81]
    v_pk_mul_f32 v[18:19], v[18:19], v[82:83]
    v_pk_mul_f32 v[20:21], v[20:21], v[84:85]
    v_pk_mul_f32 v[22:23], v[22:23], v[86:87]
    v_pk_mul_f32 v[24:25], v[24:25], v[88:89]
    v_pk_mul_f32 v[26:27], v[26:27], v[90:91]
    v_pk_mul_f32 v[28:29], v[28:29], v[92:93]
    v_pk_mul_f32 v[30:31], v[30:31], v[94:95]
    v_cvt_pk_bf16_f32 v96, v16, v17
    v_cvt_pk_bf16_f32 v97, v18, v19
    v_cvt_pk_bf16_f32 v98, v20, v21
    v_cvt_pk_bf16_f32 v99, v22, v23
    v_cvt_pk_bf16_f32 v100, v24, v25
    v_cvt_pk_bf16_f32 v101, v26, v27
    v_cvt_pk_bf16_f32 v102, v28, v29
    v_cvt_pk_bf16_f32 v103, v30, v31
    global_store_dwordx4 v2, v[96:99], s[68:69] sc1
    global_store_dwordx4 v2, v[100:103], s[68:69] offset:1024 sc1
    v_pk_fma_f32 v[32:33], v[128:129], v[10:11], v[32:33] op_sel_hi:[1,0,1] neg_lo:[0,1,0] neg_hi:[0,1,0]
    v_pk_fma_f32 v[34:35], v[130:131], v[10:11], v[34:35] op_sel_hi:[1,0,1] neg_lo:[0,1,0] neg_hi:[0,1,0]
    v_pk_fma_f32 v[36:37], v[132:133], v[10:11], v[36:37] op_sel_hi:[1,0,1] neg_lo:[0,1,0] neg_hi:[0,1,0]
    v_pk_fma_f32 v[38:39], v[134:135], v[10:11], v[38:39] op_sel_hi:[1,0,1] neg_lo:[0,1,0] neg_hi:[0,1,0]
    v_pk_fma_f32 v[40:41], v[136:137], v[10:11], v[40:41] op_sel_hi:[1,0,1] neg_lo:[0,1,0] neg_hi:[0,1,0]
    v_pk_fma_f32 v[42:43], v[138:139], v[10:11], v[42:43] op_sel_hi:[1,0,1] neg_lo:[0,1,0] neg_hi:[0,1,0]
    v_pk_fma_f32 v[44:45], v[140:141], v[10:11], v[44:45] op_sel_hi:[1,0,1] neg_lo:[0,1,0] neg_hi:[0,1,0]
    v_pk_fma_f32 v[46:47], v[142:143], v[10:11], v[46:47] op_sel_hi:[1,0,1] neg_lo:[0,1,0] neg_hi:[0,1,0]
    v_pk_fma_f32 v[32:33], v[10:11], v[32:33], v[144:145] op_sel:[1,0,0] op_sel_hi:[1,1,1]
    v_pk_fma_f32 v[34:35], v[10:11], v[34:35], v[146:147] op_sel:[1,0,0] op_sel_hi:[1,1,1]
    v_pk_fma_f32 v[36:37], v[10:11], v[36:37], v[148:149] op_sel:[1,0,0] op_sel_hi:[1,1,1]
    v_pk_fma_f32 v[38:39], v[10:11], v[38:39], v[150:151] op_sel:[1,0,0] op_sel_hi:[1,1,1]
    v_pk_fma_f32 v[40:41], v[10:11], v[40:41], v[152:153] op_sel:[1,0,0] op_sel_hi:[1,1,1]
    v_pk_fma_f32 v[42:43], v[10:11], v[42:43], v[154:155] op_sel:[1,0,0] op_sel_hi:[1,1,1]
    v_pk_fma_f32 v[44:45], v[10:11], v[44:45], v[156:157] op_sel:[1,0,0] op_sel_hi:[1,1,1]
    v_pk_fma_f32 v[46:47], v[10:11], v[46:47], v[158:159] op_sel:[1,0,0] op_sel_hi:[1,1,1]
    v_exp_f32 v80, v32
    v_exp_f32 v81, v33
    v_exp_f32 v82, v34
    v_exp_f32 v83, v35
    v_exp_f32 v84, v36
    v_exp_f32 v85, v37
    v_exp_f32 v86, v38
    v_exp_f32 v87, v39
    v_exp_f32 v88, v40
    v_exp_f32 v89, v41
    v_exp_f32 v90, v42
    v_exp_f32 v91, v43
    v_exp_f32 v92, v44
    v_exp_f32 v93, v45
    v_exp_f32 v94, v46
    v_exp_f32 v95, v47
    v_pk_add_f32 v[80:81], v[80:81], 1.0 op_sel_hi:[1,0]
    v_pk_add_f32 v[82:83], v[82:83], 1.0 op_sel_hi:[1,0]
    v_pk_add_f32 v[84:85], v[84:85], 1.0 op_sel_hi:[1,0]
    v_pk_add_f32 v[86:87], v[86:87], 1.0 op_sel_hi:[1,0]
    v_pk_add_f32 v[88:89], v[88:89], 1.0 op_sel_hi:[1,0]
    v_pk_add_f32 v[90:91], v[90:91], 1.0 op_sel_hi:[1,0]
    v_pk_add_f32 v[92:93], v[92:93], 1.0 op_sel_hi:[1,0]
    v_pk_add_f32 v[94:95], v[94:95], 1.0 op_sel_hi:[1,0]
    v_rcp_f32 v80, v80
    v_rcp_f32 v81, v81
    v_rcp_f32 v82, v82
    v_rcp_f32 v83, v83
    v_rcp_f32 v84, v84
    v_rcp_f32 v85, v85
    v_rcp_f32 v86, v86
    v_rcp_f32 v87, v87
    v_rcp_f32 v88, v88
    v_rcp_f32 v89, v89
    v_rcp_f32 v90, v90
    v_rcp_f32 v91, v91
    v_rcp_f32 v92, v92
    v_rcp_f32 v93, v93
    v_rcp_f32 v94, v94
    v_rcp_f32 v95, v95
    v_pk_mul_f32 v[32:33], v[32:33], v[80:81]
    v_pk_mul_f32 v[34:35], v[34:35], v[82:83]
    v_pk_mul_f32 v[36:37], v[36:37], v[84:85]
    v_pk_mul_f32 v[38:39], v[38:39], v[86:87]
    v_pk_mul_f32 v[40:41], v[40:41], v[88:89]
    v_pk_mul_f32 v[42:43], v[42:43], v[90:91]
    v_pk_mul_f32 v[44:45], v[44:45], v[92:93]
    v_pk_mul_f32 v[46:47], v[46:47], v[94:95]
    v_cvt_pk_bf16_f32 v104, v32, v33
    v_cvt_pk_bf16_f32 v105, v34, v35
    v_cvt_pk_bf16_f32 v106, v36, v37
    v_cvt_pk_bf16_f32 v107, v38, v39
    v_cvt_pk_bf16_f32 v108, v40, v41
    v_cvt_pk_bf16_f32 v109, v42, v43
    v_cvt_pk_bf16_f32 v110, v44, v45
    v_cvt_pk_bf16_f32 v111, v46, v47
    global_store_dwordx4 v113, v[104:107], s[68:69] sc1
    global_store_dwordx4 v113, v[108:111], s[68:69] offset:1024 sc1
    s_cmp_lg_u32 s50, 1
    s_cbranch_scc1 L_f3a_w
    s_mov_b32 s80, 0
    s_waitcnt vmcnt(4)
L_f3a_p:
    v_cmp_ne_u32 vcc, s81, v72
    s_nop 0
    s_cbranch_vccz L_f3a_w
    s_add_u32 s80, s80, 1
    s_cmp_gt_u32 s80, 0x80000
    s_cbranch_scc1 L_f3a_w
    s_sleep 1
    global_load_dword v72, v122, s[14:15] offset:0 sc1
    s_waitcnt vmcnt(0)
    s_branch L_f3a_p
L_f3a_w:
    s_barrier
    s_add_u32 s10, s10, 1024
    s_branch L_join
L_stats:
    s_movk_i32 s10, 2048
    s_lshl_b32 s62, s11, 8
    s_add_u32 s70, s14, s62
    s_addc_u32 s71, s15, 0
    s_mov_b32 s62, 0xffff0000
    v_lshlrev_b32_e64 v3, 6, v0
    v_bfe_u32 v4, v1, 3, 2
    v_lshlrev_b32 v4, 6, v4
    v_and_b32 v5, 7, v1
    v_lshl_add_u32 v4, v5, 2, v4
    v_lshrrev_b32_e64 v5, 5, v1
    v_lshl_add_u32 v4, v5, 13, v4
    v_mov_b32 v16, 0
    v_mov_b32 v17, 0
    v_mov_b32 v18, 0
    v_mov_b32 v19, 0
    v_mov_b32 v20, 0
    v_mov_b32 v21, 0
    v_mov_b32 v22, 0
    v_mov_b32 v23, 0
    v_mov_b32 v24, 0
    v_mov_b32 v25, 0
    v_mov_b32 v26, 0
    v_mov_b32 v27, 0
    v_mov_b32 v28, 0
    v_mov_b32 v29, 0
    v_mov_b32 v30, 0
    v_mov_b32 v31, 0
    s_waitcnt vmcnt(7)
    v_lshlrev_b32 v32, 16, v80
    v_and_b32_e64 v33, s62, v80
    v_pk_add_f32 v[16:17], v[16:17], v[32:33]
    v_pk_fma_f32 v[24:25], v[32:33], v[32:33], v[24:25]
    v_lshlrev_b32 v34, 16, v81
    v_and_b32 v35, s62, v81
    v_pk_add_f32 v[18:19], v[18:19], v[34:35]
    v_pk_fma_f32 v[26:27], v[34:35], v[34:35], v[26:27]
    v_lshlrev_b32 v32, 16, v82
    v_and_b32 v33, s62, v82
    v_pk_add_f32 v[20:21], v[20:21], v[32:33]
    v_pk_fma_f32 v[28:29], v[32:33], v[32:33], v[28:29]
    v_lshlrev_b32 v34, 16, v83
    v_and_b32 v35, s62, v83
    v_pk_add_f32 v[22:23], v[22:23], v[34:35]
    v_pk_fma_f32 v[30:31], v[34:35], v[34:35], v[30:31]
    s_waitcnt vmcnt(6)
    v_lshlrev_b32 v32, 16, v84
    v_and_b32_e64 v33, s62, v84
    v_pk_add_f32 v[16:17], v[16:17], v[32:33]
    v_pk_fma_f32 v[24:25], v[32:33], v[32:33], v[24:25]
    v_lshlrev_b32 v34, 16, v85
    v_and_b32 v35, s62, v85
    v_pk_add_f32 v[18:19], v[18:19], v[34:35]
    v_pk_fma_f32 v[26:27], v[34:35], v[34:35], v[26:27]
    v_lshlrev_b32 v32, 16, v86
    v_and_b32 v33, s62, v86
    v_pk_add_f32 v[20:21], v[20:21], v[32:33]
    v_pk_fma_f32 v[28:29], v[32:33], v[32:33], v[28:29]
    v_lshlrev_b32 v34, 16, v87
    v_and_b32 v35, s62, v87
    v_pk_add_f32 v[22:23], v[22:23], v[34:35]
    v_pk_fma_f32 v[30:31], v[34:35], v[34:35], v[30:31]
    s_waitcnt vmcnt(5)
    v_lshlrev_b32 v32, 16, v88
    v_and_b32_e64 v33, s62, v88
    v_pk_add_f32 v[16:17], v[16:17], v[32:33]
    v_pk_fma_f32 v[24:25], v[32:33], v[32:33], v[24:25]
    v_lshlrev_b32 v34, 16, v89
    v_and_b32 v35, s62, v89
    v_pk_add_f32 v[18:19], v[18:19], v[34:35]
    v_pk_fma_f32 v[26:27], v[34:35], v[34:35], v[26:27]
    v_lshlrev_b32 v32, 16, v90
    v_and_b32 v33, s62, v90
    v_pk_add_f32 v[20:21], v[20:21], v[32:33]
    v_pk_fma_f32 v[28:29], v[32:33], v[32:33], v[28:29]
    v_lshlrev_b32 v34, 16, v91
    v_and_b32 v35, s62, v91
    v_pk_add_f32 v[22:23], v[22:23], v[34:35]
    v_pk_fma_f32 v[30:31], v[34:35], v[34:35], v[30:31]
    s_waitcnt vmcnt(4)
    v_lshlrev_b32 v32, 16, v92
    v_and_b32_e64 v33, s62, v92
    v_pk_add_f32 v[16:17], v[16:17], v[32:33]
    v_pk_fma_f32 v[24:25], v[32:33], v[32:33], v[24:25]
    v_lshlrev_b32 v34, 16, v93
    v_and_b32 v35, s62, v93
    v_pk_add_f32 v[18:19], v[18:19], v[34:35]
    v_pk_fma_f32 v[26:27], v[34:35], v[34:35], v[26:27]
    v_lshlrev_b32 v32, 16, v94
    v_and_b32 v33, s62, v94
    v_pk_add_f32 v[20:21], v[20:21], v[32:33]
    v_pk_fma_f32 v[28:29], v[32:33], v[32:33], v[28:29]
    v_lshlrev_b32 v34, 16, v95
    v_and_b32 v35, s62, v95
    v_pk_add_f32 v[22:23], v[22:23], v[34:35]
    v_pk_fma_f32 v[30:31], v[34:35], v[34:35], v[30:31]
    s_waitcnt vmcnt(3)
    v_lshlrev_b32 v32, 16, v96
    v_and_b32_e64 v33, s62, v96
    v_pk_add_f32 v[16:17], v[16:17], v[32:33]
    v_pk_fma_f32 v[24:25], v[32:33], v[32:33], v[24:25]
    v_lshlrev_b32 v34, 16, v97
    v_and_b32 v35, s62, v97
    v_pk_add_f32 v[18:19], v[18:19], v[34:35]
    v_pk_fma_f32 v[26:27], v[34:35], v[34:35], v[26:27]
    v_lshlrev_b32 v32, 16, v98
    v_and_b32 v33, s62, v98
    v_pk_add_f32 v[20:21], v[20:21], v[32:33]
    v_pk_fma_f32 v[28:29], v[32:33], v[32:33], v[28:29]
    v_lshlrev_b32 v34, 16, v99
    v_and_b32 v35, s62, v99
    v_pk_add_f32 v[22:23], v[22:23], v[34:35]
    v_pk_fma_f32 v[30:31], v[34:35], v[34:35], v[30:31]
    s_waitcnt vmcnt(2)
    v_lshlrev_b32 v32, 16, v100
    v_and_b32_e64 v33, s62, v100
    v_pk_add_f32 v[16:17], v[16:17], v[32:33]
    v_pk_fma_f32 v[24:25], v[32:33], v[32:33], v[24:25]
    v_lshlrev_b32 v34, 16, v101
    v_and_b32 v35, s62, v101
    v_pk_add_f32 v[18:19], v[18:19], v[34:35]
    v_pk_fma_f32 v[26:27], v[34:35], v[34:35], v[26:27]
    v_lshlrev_b32 v32, 16, v102
    v_and_b32 v33, s62, v102
    v_pk_add_f32 v[20:21], v[20:21], v[32:33]
    v_pk_fma_f32 v[28:29], v[32:33], v[32:33], v[28:29]
    v_lshlrev_b32 v34, 16, v103
    v_and_b32 v35, s62, v103
    v_pk_add_f32 v[22:23], v[22:23], v[34:35]
    v_pk_fma_f32 v[30:31], v[34:35], v[34:35], v[30:31]
    s_waitcnt vmcnt(1)
    v_lshlrev_b32 v32, 16, v104
    v_and_b32_e64 v33, s62, v104
    v_pk_add_f32 v[16:17], v[16:17], v[32:33]
    v_pk_fma_f32 v[24:25], v[32:33], v[32:33], v[24:25]
    v_lshlrev_b32 v34, 16, v105
    v_and_b32 v35, s62, v105
    v_pk_add_f32 v[18:19], v[18:19], v[34:35]
    v_pk_fma_f32 v[26:27], v[34:35], v[34:35], v[26:27]
    v_lshlrev_b32 v32, 16, v106
    v_and_b32 v33, s62, v106
    v_pk_add_f32 v[20:21], v[20:21], v[32:33]
    v_pk_fma_f32 v[28:29], v[32:33], v[32:33], v[28:29]
    v_lshlrev_b32 v34, 16, v107
    v_and_b32 v35, s62, v107
    v_pk_add_f32 v[22:23], v[22:23], v[34:35]
    v_pk_fma_f32 v[30:31], v[34:35], v[34:35], v[30:31]
    s_waitcnt vmcnt(0)
    v_lshlrev_b32 v32, 16, v108
    v_and_b32_e64 v33, s62, v108
    v_pk_add_f32 v[16:17], v[16:17], v[32:33]
    v_pk_fma_f32 v[24:25], v[32:33], v[32:33], v[24:25]
    v_lshlrev_b32 v34, 16, v109
    v_and_b32 v35, s62, v109
    v_pk_add_f32 v[18:19], v[18:19], v[34:35]
    v_pk_fma_f32 v[26:27], v[34:35], v[34:35], v[26:27]
    v_lshlrev_b32 v32, 16, v110
    v_and_b32 v33, s62, v110
    v_pk_add_f32 v[20:21], v[20:21], v[32:33]
    v_pk_fma_f32 v[28:29], v[32:33], v[32:33], v[28:29]
    v_lshlrev_b32 v34, 16, v111
    v_and_b32 v35, s62, v111
    v_pk_add_f32 v[22:23], v[22:23], v[34:35]
    v_pk_fma_f32 v[30:31], v[34:35], v[34:35], v[30:31]
    v_add_f32_dpp v16, v16, v16 row_ror:4 row_mask:0xf bank_mask:0xf
    v_add_f32_dpp v17, v17, v17 row_ror:4 row_mask:0xf bank_mask:0xf
    v_add_f32_dpp v18, v18, v18 row_ror:4 row_mask:0xf bank_mask:0xf
    v_add_f32_dpp v19, v19, v19 row_ror:4 row_mask:0xf bank_mask:0xf
    v_add_f32_dpp v20, v20, v20 row_ror:4 row_mask:0xf bank_mask:0xf
    v_add_f32_dpp v21, v21, v21 row_ror:4 row_mask:0xf bank_mask:0xf
    v_add_f32_dpp v22, v22, v22 row_ror:4 row_mask:0xf bank_mask:0xf
    v_add_f32_dpp v23, v23, v23 row_ror:4 row_mask:0xf bank_mask:0xf
    v_add_f32_dpp v24, v24, v24 row_ror:4 row_mask:0xf bank_mask:0xf
    v_add_f32_dpp v25, v25, v25 row_ror:4 row_mask:0xf bank_mask:0xf
    v_add_f32_dpp v26, v26, v26 row_ror:4 row_mask:0xf bank_mask:0xf
    v_add_f32_dpp v27, v27, v27 row_ror:4 row_mask:0xf bank_mask:0xf
    v_add_f32_dpp v28, v28, v28 row_ror:4 row_mask:0xf bank_mask:0xf
    v_add_f32_dpp v29, v29, v29 row_ror:4 row_mask:0xf bank_mask:0xf
    v_add_f32_dpp v30, v30, v30 row_ror:4 row_mask:0xf bank_mask:0xf
    v_add_f32_dpp v31, v31, v31 row_ror:4 row_mask:0xf bank_mask:0xf
    v_add_f32_dpp v16, v16, v16 row_ror:8 row_mask:0xf bank_mask:0xf
    v_add_f32_dpp v17, v17, v17 row_ror:8 row_mask:0xf bank_mask:0xf
    v_add_f32_dpp v18, v18, v18 row_ror:8 row_mask:0xf bank_mask:0xf
    v_add_f32_dpp v19, v19, v19 row_ror:8 row_mask:0xf bank_mask:0xf
    v_add_f32_dpp v20, v20, v20 row_ror:8 row_mask:0xf bank_mask:0xf
    v_add_f32_dpp v21, v21, v21 row_ror:8 row_mask:0xf bank_mask:0xf
    v_add_f32_dpp v22, v22, v22 row_ror:8 row_mask:0xf bank_mask:0xf
    v_add_f32_dpp v23, v23, v23 row_ror:8 row_mask:0xf bank_mask:0xf
    v_add_f32_dpp v24, v24, v24 row_ror:8 row_mask:0xf bank_mask:0xf
    v_add_f32_dpp v25, v25, v25 row_ror:8 row_mask:0xf bank_mask:0xf
    v_add_f32_dpp v26, v26, v26 row_ror:8 row_mask:0xf bank_mask:0xf
    v_add_f32_dpp v27, v27, v27 row_ror:8 row_mask:0xf bank_mask:0xf
    v_add_f32_dpp v28, v28, v28 row_ror:8 row_mask:0xf bank_mask:0xf
    v_add_f32_dpp v29, v29, v29 row_ror:8 row_mask:0xf bank_mask:0xf
    v_add_f32_dpp v30, v30, v30 row_ror:8 row_mask:0xf bank_mask:0xf
    v_add_f32_dpp v31, v31, v31 row_ror:8 row_mask:0xf bank_mask:0xf
    ds_write_b128 v3, v[16:19] offset:0
    ds_write_b128 v3, v[20:23] offset:16
    ds_write_b128 v3, v[24:27] offset:32
    ds_write_b128 v3, v[28:31] offset:48
    s_waitcnt lgkmcnt(0)
    s_barrier
    s_cmp_lg_u32 s50, 0
    s_cbranch_scc1 L_st0
    ds_read_b32 v16, v4 offset:0
    ds_read_b32 v17, v4 offset:32
    ds_read_b32 v18, v4 offset:1024
    ds_read_b32 v19, v4 offset:1056
    ds_read_b32 v20, v4 offset:2048
    ds_read_b32 v21, v4 offset:2080
    ds_read_b32 v22, v4 offset:3072
    ds_read_b32 v23, v4 offset:3104
    ds_read_b32 v24, v4 offset:4096
    ds_read_b32 v25, v4 offset:4128
    ds_read_b32 v26, v4 offset:5120
    ds_read_b32 v27, v4 offset:5152
    ds_read_b32 v28, v4 offset:6144
    ds_read_b32 v29, v4 offset:6176
    ds_read_b32 v30, v4 offset:7168
    ds_read_b32 v31, v4 offset:7200
    s_nop 0
    s_waitcnt lgkmcnt(0)
    v_pk_add_f32 v[16:17], v[16:17], v[18:19]
    v_pk_add_f32 v[16:17], v[16:17], v[20:21]
    v_pk_add_f32 v[16:17], v[16:17], v[22:23]
    v_pk_add_f32 v[16:17], v[16:17], v[24:25]
    v_pk_add_f32 v[16:17], v[16:17], v[26:27]
    v_pk_add_f32 v[16:17], v[16:17], v[28:29]
    v_pk_add_f32 v[16:17], v[16:17], v[30:31]
    v_mov_b64 v[18:19], v[16:17]
    s_nop 1
    v_permlane32_swap_b32 v16, v18
    v_permlane32_swap_b32 v17, v19
    v_pk_add_f32 v[16:17], v[16:17], v[18:19]
    v_mul_f32 v16, 0x3b000000, v16
    v_mul_f32 v17, 0x3b000000, v17
    v_fma_f32 v17, -v16, v16, v17
    v_max_f32_e64 v17, 0, v17
    v_add_f32 v17, 0x3727c5ac, v17
    v_rsq_f32 v17, v17
    s_nop 0
    v_mul_f32 v17, 0xbfb8aa3b, v17
    global_store_dwordx2 v6, v[16:17], s[70:71] sc1
L_st0:
    s_cmp_lg_u32 s50, 1
    s_cbranch_scc1 L_sf2b_w
    s_mov_b32 s80, 0
    global_load_dwordx4 v[72:75], v126, s[14:15] sc1
L_sf2b_p:
    s_waitcnt vmcnt(0)
    v_xor_b32 v80, s81, v72
    v_xor_b32 v81, s81, v73
    v_or_b32 v80, v80, v81
    v_xor_b32 v81, s81, v74
    v_or_b32 v80, v80, v81
    v_xor_b32 v81, s81, v75
    v_or_b32_e64 v80, v80, v81
    v_cmp_ne_u32 vcc, 0, v80
    s_nop 0
    s_cbranch_vccz L_sf2b_w
    s_add_u32 s80, s80, 1
    s_cmp_gt_u32 s80, 0x80000
    s_cbranch_scc1 L_sf2b_w
    s_sleep 1
    global_load_dwordx4 v[72:75], v126, s[14:15] sc1
    s_branch L_sf2b_p
L_sf2b_w:
    s_barrier
    s_add_u32 s28, s28, 0x100000
    s_addc_u32 s29, s29, 0
    s_add_u32 s70, s70, 0x2000
    s_addc_u32 s71, s71, 0
    global_load_dwordx4 v[80:83], v2, s[28:29] offset:0 sc1
    global_load_dwordx4 v[84:87], v2, s[28:29] offset:1024 sc1
    global_load_dwordx4 v[88:91], v2, s[28:29] offset:2048 sc1
    global_load_dwordx4 v[92:95], v2, s[28:29] offset:3072 sc1
    global_load_dwordx4 v[96:99], v7, s[28:29] offset:0 sc1
    global_load_dwordx4 v[100:103], v7, s[28:29] offset:1024 sc1
    global_load_dwordx4 v[104:107], v7, s[28:29] offset:2048 sc1
    global_load_dwordx4 v[108:111], v7, s[28:29] offset:3072 sc1
    v_mov_b32 v16, 0
    v_mov_b32 v17, 0
    v_mov_b32 v18, 0
    v_mov_b32 v19, 0
    v_mov_b32 v20, 0
    v_mov_b32 v21, 0
    v_mov_b32 v22, 0
    v_mov_b32 v23, 0
    v_mov_b32 v24, 0
    v_mov_b32 v25, 0
    v_mov_b32 v26, 0
    v_mov_b32 v27, 0
    v_mov_b32 v28, 0
    v_mov_b32 v29, 0
    v_mov_b32 v30, 0
    v_mov_b32 v31, 0
    s_waitcnt vmcnt(7)
    v_lshlrev_b32 v32, 16, v80
    v_and_b32_e64 v33, s62, v80
    v_pk_add_f32 v[16:17], v[16:17], v[32:33]
    v_pk_fma_f32 v[24:25], v[32:33], v[32:33], v[24:25]
    v_lshlrev_b32 v34, 16, v81
    v_and_b32 v35, s62, v81
    v_pk_add_f32 v[18:19], v[18:19], v[34:35]
    v_pk_fma_f32 v[26:27], v[34:35], v[34:35], v[26:27]
    v_lshlrev_b32 v32, 16, v82
    v_and_b32 v33, s62, v82
    v_pk_add_f32 v[20:21], v[20:21], v[32:33]
    v_pk_fma_f32 v[28:29], v[32:33], v[32:33], v[28:29]
    v_lshlrev_b32 v34, 16, v83
    v_and_b32 v35, s62, v83
    v_pk_add_f32 v[22:23], v[22:23], v[34:35]
    v_pk_fma_f32 v[30:31], v[34:35], v[34:35], v[30:31]
    s_waitcnt vmcnt(6)
    v_lshlrev_b32 v32, 16, v84
    v_and_b32_e64 v33, s62, v84
    v_pk_add_f32 v[16:17], v[16:17], v[32:33]
    v_pk_fma_f32 v[24:25], v[32:33], v[32:33], v[24:25]
    v_lshlrev_b32 v34, 16, v85
    v_and_b32 v35, s62, v85
    v_pk_add_f32 v[18:19], v[18:19], v[34:35]
    v_pk_fma_f32 v[26:27], v[34:35], v[34:35], v[26:27]
    v_lshlrev_b32 v32, 16, v86
    v_and_b32 v33, s62, v86
    v_pk_add_f32 v[20:21], v[20:21], v[32:33]
    v_pk_fma_f32 v[28:29], v[32:33], v[32:33], v[28:29]
    v_lshlrev_b32 v34, 16, v87
    v_and_b32 v35, s62, v87
    v_pk_add_f32 v[22:23], v[22:23], v[34:35]
    v_pk_fma_f32 v[30:31], v[34:35], v[34:35], v[30:31]
    s_waitcnt vmcnt(5)
    v_lshlrev_b32 v32, 16, v88
    v_and_b32_e64 v33, s62, v88
    v_pk_add_f32 v[16:17], v[16:17], v[32:33]
    v_pk_fma_f32 v[24:25], v[32:33], v[32:33], v[24:25]
    v_lshlrev_b32 v34, 16, v89
    v_and_b32 v35, s62, v89
    v_pk_add_f32 v[18:19], v[18:19], v[34:35]
    v_pk_fma_f32 v[26:27], v[34:35], v[34:35], v[26:27]
    v_lshlrev_b32 v32, 16, v90
    v_and_b32 v33, s62, v90
    v_pk_add_f32 v[20:21], v[20:21], v[32:33]
    v_pk_fma_f32 v[28:29], v[32:33], v[32:33], v[28:29]
    v_lshlrev_b32 v34, 16, v91
    v_and_b32 v35, s62, v91
    v_pk_add_f32 v[22:23], v[22:23], v[34:35]
    v_pk_fma_f32 v[30:31], v[34:35], v[34:35], v[30:31]
    s_waitcnt vmcnt(4)
    v_lshlrev_b32 v32, 16, v92
    v_and_b32_e64 v33, s62, v92
    v_pk_add_f32 v[16:17], v[16:17], v[32:33]
    v_pk_fma_f32 v[24:25], v[32:33], v[32:33], v[24:25]
    v_lshlrev_b32 v34, 16, v93
    v_and_b32 v35, s62, v93
    v_pk_add_f32 v[18:19], v[18:19], v[34:35]
    v_pk_fma_f32 v[26:27], v[34:35], v[34:35], v[26:27]
    v_lshlrev_b32 v32, 16, v94
    v_and_b32 v33, s62, v94
    v_pk_add_f32 v[20:21], v[20:21], v[32:33]
    v_pk_fma_f32 v[28:29], v[32:33], v[32:33], v[28:29]
    v_lshlrev_b32 v34, 16, v95
    v_and_b32 v35, s62, v95
    v_pk_add_f32 v[22:23], v[22:23], v[34:35]
    v_pk_fma_f32 v[30:31], v[34:35], v[34:35], v[30:31]
    s_waitcnt vmcnt(3)
    v_lshlrev_b32 v32, 16, v96
    v_and_b32_e64 v33, s62, v96
    v_pk_add_f32 v[16:17], v[16:17], v[32:33]
    v_pk_fma_f32 v[24:25], v[32:33], v[32:33], v[24:25]
    v_lshlrev_b32 v34, 16, v97
    v_and_b32 v35, s62, v97
    v_pk_add_f32 v[18:19], v[18:19], v[34:35]
    v_pk_fma_f32 v[26:27], v[34:35], v[34:35], v[26:27]
    v_lshlrev_b32 v32, 16, v98
    v_and_b32 v33, s62, v98
    v_pk_add_f32 v[20:21], v[20:21], v[32:33]
    v_pk_fma_f32 v[28:29], v[32:33], v[32:33], v[28:29]
    v_lshlrev_b32 v34, 16, v99
    v_and_b32 v35, s62, v99
    v_pk_add_f32 v[22:23], v[22:23], v[34:35]
    v_pk_fma_f32 v[30:31], v[34:35], v[34:35], v[30:31]
    s_waitcnt vmcnt(2)
    v_lshlrev_b32 v32, 16, v100
    v_and_b32_e64 v33, s62, v100
    v_pk_add_f32 v[16:17], v[16:17], v[32:33]
    v_pk_fma_f32 v[24:25], v[32:33], v[32:33], v[24:25]
    v_lshlrev_b32 v34, 16, v101
    v_and_b32 v35, s62, v101
    v_pk_add_f32 v[18:19], v[18:19], v[34:35]
    v_pk_fma_f32 v[26:27], v[34:35], v[34:35], v[26:27]
    v_lshlrev_b32 v32, 16, v102
    v_and_b32 v33, s62, v102
    v_pk_add_f32 v[20:21], v[20:21], v[32:33]
    v_pk_fma_f32 v[28:29], v[32:33], v[32:33], v[28:29]
    v_lshlrev_b32 v34, 16, v103
    v_and_b32 v35, s62, v103
    v_pk_add_f32 v[22:23], v[22:23], v[34:35]
    v_pk_fma_f32 v[30:31], v[34:35], v[34:35], v[30:31]
    s_waitcnt vmcnt(1)
    v_lshlrev_b32 v32, 16, v104
    v_and_b32_e64 v33, s62, v104
    v_pk_add_f32 v[16:17], v[16:17], v[32:33]
    v_pk_fma_f32 v[24:25], v[32:33], v[32:33], v[24:25]
    v_lshlrev_b32 v34, 16, v105
    v_and_b32 v35, s62, v105
    v_pk_add_f32 v[18:19], v[18:19], v[34:35]
    v_pk_fma_f32 v[26:27], v[34:35], v[34:35], v[26:27]
    v_lshlrev_b32 v32, 16, v106
    v_and_b32 v33, s62, v106
    v_pk_add_f32 v[20:21], v[20:21], v[32:33]
    v_pk_fma_f32 v[28:29], v[32:33], v[32:33], v[28:29]
    v_lshlrev_b32 v34, 16, v107
    v_and_b32 v35, s62, v107
    v_pk_add_f32 v[22:23], v[22:23], v[34:35]
    v_pk_fma_f32 v[30:31], v[34:35], v[34:35], v[30:31]
    s_waitcnt vmcnt(0)
    v_lshlrev_b32 v32, 16, v108
    v_and_b32_e64 v33, s62, v108
    v_pk_add_f32 v[16:17], v[16:17], v[32:33]
    v_pk_fma_f32 v[24:25], v[32:33], v[32:33], v[24:25]
    v_lshlrev_b32 v34, 16, v109
    v_and_b32 v35, s62, v109
    v_pk_add_f32 v[18:19], v[18:19], v[34:35]
    v_pk_fma_f32 v[26:27], v[34:35], v[34:35], v[26:27]
    v_lshlrev_b32 v32, 16, v110
    v_and_b32 v33, s62, v110
    v_pk_add_f32 v[20:21], v[20:21], v[32:33]
    v_pk_fma_f32 v[28:29], v[32:33], v[32:33], v[28:29]
    v_lshlrev_b32 v34, 16, v111
    v_and_b32 v35, s62, v111
    v_pk_add_f32 v[22:23], v[22:23], v[34:35]
    v_pk_fma_f32 v[30:31], v[34:35], v[34:35], v[30:31]
    v_add_f32_dpp v16, v16, v16 row_ror:4 row_mask:0xf bank_mask:0xf
    v_add_f32_dpp v17, v17, v17 row_ror:4 row_mask:0xf bank_mask:0xf
    v_add_f32_dpp v18, v18, v18 row_ror:4 row_mask:0xf bank_mask:0xf
    v_add_f32_dpp v19, v19, v19 row_ror:4 row_mask:0xf bank_mask:0xf
    v_add_f32_dpp v20, v20, v20 row_ror:4 row_mask:0xf bank_mask:0xf
    v_add_f32_dpp v21, v21, v21 row_ror:4 row_mask:0xf bank_mask:0xf
    v_add_f32_dpp v22, v22, v22 row_ror:4 row_mask:0xf bank_mask:0xf
    v_add_f32_dpp v23, v23, v23 row_ror:4 row_mask:0xf bank_mask:0xf
    v_add_f32_dpp v24, v24, v24 row_ror:4 row_mask:0xf bank_mask:0xf
    v_add_f32_dpp v25, v25, v25 row_ror:4 row_mask:0xf bank_mask:0xf
    v_add_f32_dpp v26, v26, v26 row_ror:4 row_mask:0xf bank_mask:0xf
    v_add_f32_dpp v27, v27, v27 row_ror:4 row_mask:0xf bank_mask:0xf
    v_add_f32_dpp v28, v28, v28 row_ror:4 row_mask:0xf bank_mask:0xf
    v_add_f32_dpp v29, v29, v29 row_ror:4 row_mask:0xf bank_mask:0xf
    v_add_f32_dpp v30, v30, v30 row_ror:4 row_mask:0xf bank_mask:0xf
    v_add_f32_dpp v31, v31, v31 row_ror:4 row_mask:0xf bank_mask:0xf
    v_add_f32_dpp v16, v16, v16 row_ror:8 row_mask:0xf bank_mask:0xf
    v_add_f32_dpp v17, v17, v17 row_ror:8 row_mask:0xf bank_mask:0xf
    v_add_f32_dpp v18, v18, v18 row_ror:8 row_mask:0xf bank_mask:0xf
    v_add_f32_dpp v19, v19, v19 row_ror:8 row_mask:0xf bank_mask:0xf
    v_add_f32_dpp v20, v20, v20 row_ror:8 row_mask:0xf bank_mask:0xf
    v_add_f32_dpp v21, v21, v21 row_ror:8 row_mask:0xf bank_mask:0xf
    v_add_f32_dpp v22, v22, v22 row_ror:8 row_mask:0xf bank_mask:0xf
    v_add_f32_dpp v23, v23, v23 row_ror:8 row_mask:0xf bank_mask:0xf
    v_add_f32_dpp v24, v24, v24 row_ror:8 row_mask:0xf bank_mask:0xf
    v_add_f32_dpp v25, v25, v25 row_ror:8 row_mask:0xf bank_mask:0xf
    v_add_f32_dpp v26, v26, v26 row_ror:8 row_mask:0xf bank_mask:0xf
    v_add_f32_dpp v27, v27, v27 row_ror:8 row_mask:0xf bank_mask:0xf
    v_add_f32_dpp v28, v28, v28 row_ror:8 row_mask:0xf bank_mask:0xf
    v_add_f32_dpp v29, v29, v29 row_ror:8 row_mask:0xf bank_mask:0xf
    v_add_f32_dpp v30, v30, v30 row_ror:8 row_mask:0xf bank_mask:0xf
    v_add_f32_dpp v31, v31, v31 row_ror:8 row_mask:0xf bank_mask:0xf
    ds_write_b128 v3, v[16:19] offset:16384
    ds_write_b128 v3, v[20:23] offset:16400
    ds_write_b128 v3, v[24:27] offset:16416
    ds_write_b128 v3, v[28:31] offset:16432
    s_waitcnt lgkmcnt(0)
    s_barrier
    s_cmp_lg_u32 s50, 0
    s_cbranch_scc1 L_st1
    ds_read_b32 v16, v4 offset:16384
    ds_read_b32 v17, v4 offset:16416
    ds_read_b32 v18, v4 offset:17408
    ds_read_b32 v19, v4 offset:17440
    ds_read_b32 v20, v4 offset:18432
    ds_read_b32 v21, v4 offset:18464
    ds_read_b32 v22, v4 offset:19456
    ds_read_b32 v23, v4 offset:19488
    ds_read_b32 v24, v4 offset:20480
    ds_read_b32 v25, v4 offset:20512
    ds_read_b32 v26, v4 offset:21504
    ds_read_b32 v27, v4 offset:21536
    ds_read_b32 v28, v4 offset:22528
    ds_read_b32 v29, v4 offset:22560
    ds_read_b32 v30, v4 offset:23552
    ds_read_b32 v31, v4 offset:23584
    s_nop 0
    s_waitcnt lgkmcnt(0)
    v_pk_add_f32 v[16:17], v[16:17], v[18:19]
    v_pk_add_f32 v[16:17], v[16:17], v[20:21]
    v_pk_add_f32 v[16:17], v[16:17], v[22:23]
    v_pk_add_f32 v[16:17], v[16:17], v[24:25]
    v_pk_add_f32 v[16:17], v[16:17], v[26:27]
    v_pk_add_f32 v[16:17], v[16:17], v[28:29]
    v_pk_add_f32 v[16:17], v[16:17], v[30:31]
    v_mov_b64 v[18:19], v[16:17]
    s_nop 1
    v_permlane32_swap_b32 v16, v18
    v_permlane32_swap_b32 v17, v19
    v_pk_add_f32 v[16:17], v[16:17], v[18:19]
    v_mul_f32 v16, 0x3b000000, v16
    v_mul_f32 v17, 0x3b000000, v17
    v_fma_f32 v17, -v16, v16, v17
    v_max_f32_e64 v17, 0, v17
    v_add_f32 v17, 0x3727c5ac, v17
    v_rsq_f32 v17, v17
    s_nop 0
    v_mul_f32 v17, 0xbfb8aa3b, v17
    global_store_dwordx2 v6, v[16:17], s[70:71] sc1
L_st1:
    global_load_dwordx4 a[128:131], v2, s[32:33] offset:0 sc1
    global_load_dwordx4 a[132:135], v113, s[32:33] offset:0 sc1
    global_load_dwordx4 a[136:139], v2, s[32:33] offset:1024 sc1
    global_load_dwordx4 a[140:143], v113, s[32:33] offset:1024 sc1
    global_load_dwordx4 a[144:147], v2, s[32:33] offset:2048 sc1
    global_load_dwordx4 a[148:151], v113, s[32:33] offset:2048 sc1
    global_load_dwordx4 a[152:155], v2, s[32:33] offset:3072 sc1
    global_load_dwordx4 a[156:159], v113, s[32:33] offset:3072 sc1
    s_add_u32 s32, s32, 4096
    s_nop 0
    s_addc_u32 s33, s33, 0
    global_load_dwordx4 a[160:163], v2, s[32:33] offset:0 sc1
    global_load_dwordx4 a[164:167], v113, s[32:33] offset:0 sc1
    global_load_dwordx4 a[168:171], v2, s[32:33] offset:1024 sc1
    global_load_dwordx4 a[172:175], v113, s[32:33] offset:1024 sc1
    global_load_dwordx4 a[176:179], v2, s[32:33] offset:2048 sc1
    global_load_dwordx4 a[180:183], v113, s[32:33] offset:2048 sc1
    global_load_dwordx4 a[184:187], v2, s[32:33] offset:3072 sc1
    global_load_dwordx4 a[188:191], v113, s[32:33] offset:3072 sc1
    s_add_u32 s32, s32, 4096
    s_nop 0
    s_addc_u32 s33, s33, 0
    global_load_dwordx4 a[192:195], v2, s[32:33] offset:0 sc1
    global_load_dwordx4 a[196:199], v113, s[32:33] offset:0 sc1
    global_load_dwordx4 a[200:203], v2, s[32:33] offset:1024 sc1
    global_load_dwordx4 a[204:207], v113, s[32:33] offset:1024 sc1
    global_load_dwordx4 a[208:211], v2, s[32:33] offset:2048 sc1
    global_load_dwordx4 a[212:215], v113, s[32:33] offset:2048 sc1
    global_load_dwordx4 a[216:219], v2, s[32:33] offset:3072 sc1
    global_load_dwordx4 a[220:223], v113, s[32:33] offset:3072 sc1
    s_add_u32 s32, s32, 4096
    s_nop 0
    s_addc_u32 s33, s33, 0
    global_load_dwordx4 a[224:227], v2, s[32:33] offset:0 sc1
    global_load_dwordx4 a[228:231], v113, s[32:33] offset:0 sc1
    global_load_dwordx4 a[232:235], v2, s[32:33] offset:1024 sc1
    global_load_dwordx4 a[236:239], v113, s[32:33] offset:1024 sc1
    global_load_dwordx4 a[240:243], v2, s[32:33] offset:2048 sc1
    global_load_dwordx4 a[244:247], v113, s[32:33] offset:2048 sc1
    global_load_dwordx4 a[248:251], v2, s[32:33] offset:3072 sc1
    global_load_dwordx4 a[252:255], v113, s[32:33] offset:3072 sc1
    s_add_u32 s32, s32, 4096
    s_nop 0
    s_addc_u32 s33, s33, 0
    global_load_dwordx4 v[160:163], v2, s[32:33] offset:0 sc1
    global_load_dwordx4 v[164:167], v113, s[32:33] offset:0 sc1
    global_load_dwordx4 v[168:171], v2, s[32:33] offset:1024 sc1
    global_load_dwordx4 v[172:175], v113, s[32:33] offset:1024 sc1
    global_load_dwordx4 v[176:179], v2, s[32:33] offset:2048 sc1
    global_load_dwordx4 v[180:183], v113, s[32:33] offset:2048 sc1
    global_load_dwordx4 v[184:187], v2, s[32:33] offset:3072 sc1
    global_load_dwordx4 v[188:191], v113, s[32:33] offset:3072 sc1
    s_add_u32 s32, s32, 4096
    s_nop 0
    s_addc_u32 s33, s33, 0
    global_load_dwordx4 v[192:195], v2, s[32:33] offset:0 sc1
    global_load_dwordx4 v[196:199], v113, s[32:33] offset:0 sc1
    global_load_dwordx4 v[200:203], v2, s[32:33] offset:1024 sc1
    global_load_dwordx4 v[204:207], v113, s[32:33] offset:1024 sc1
    global_load_dwordx4 v[208:211], v2, s[32:33] offset:2048 sc1
    global_load_dwordx4 v[212:215], v113, s[32:33] offset:2048 sc1
    global_load_dwordx4 v[216:219], v2, s[32:33] offset:3072 sc1
    global_load_dwordx4 v[220:223], v113, s[32:33] offset:3072 sc1
    s_add_u32 s32, s32, 4096
    s_nop 0
    s_addc_u32 s33, s33, 0
    global_load_dwordx4 v[224:227], v2, s[32:33] offset:0 sc1
    global_load_dwordx4 v[228:231], v113, s[32:33] offset:0 sc1
    global_load_dwordx4 v[232:235], v2, s[32:33] offset:1024 sc1
    global_load_dwordx4 v[236:239], v113, s[32:33] offset:1024 sc1
    global_load_dwordx4 v[240:243], v2, s[32:33] offset:2048 sc1
    global_load_dwordx4 v[244:247], v113, s[32:33] offset:2048 sc1
    global_load_dwordx4 v[248:251], v2, s[32:33] offset:3072 sc1
    global_load_dwordx4 v[252:255], v113, s[32:33] offset:3072 sc1
    s_cmp_lg_u32 s50, 1
    s_cbranch_scc1 L_sf3a_w
    s_mov_b32 s80, 0
    global_load_dword v72, v122, s[14:15] offset:0 sc1
L_sf3a_p:
    s_waitcnt vmcnt(0)
    v_cmp_ne_u32 vcc, s81, v72
    s_nop 0
    s_cbranch_vccz L_sf3a_w
    s_add_u32 s80, s80, 1
    s_cmp_gt_u32 s80, 0x80000
    s_cbranch_scc1 L_sf3a_w
    s_sleep 1
    global_load_dword v72, v122, s[14:15] offset:0 sc1
    s_branch L_sf3a_p
L_sf3a_w:
    s_barrier
L_join:
    global_load_dwordx4 a[0:3], v2, s[22:23] offset:0 sc1
    global_load_dwordx4 a[4:7], v2, s[22:23] offset:1024 sc1
    global_load_dwordx4 a[8:11], v2, s[22:23] offset:2048 sc1
    global_load_dwordx4 a[12:15], v2, s[22:23] offset:3072 sc1
    s_add_u32 s22, s22, 4096
    s_addc_u32 s23, s23, 0
    global_load_dwordx4 a[16:19], v2, s[22:23] offset:0 sc1
    global_load_dwordx4 a[20:23], v2, s[22:23] offset:1024 sc1
    global_load_dwordx4 a[24:27], v2, s[22:23] offset:2048 sc1
    global_load_dwordx4 a[28:31], v2, s[22:23] offset:3072 sc1
    s_add_u32 s22, s22, 4096
    s_addc_u32 s23, s23, 0
    global_load_dwordx4 a[32:35], v2, s[22:23] offset:0 sc1
    global_load_dwordx4 a[36:39], v2, s[22:23] offset:1024 sc1
    global_load_dwordx4 a[40:43], v2, s[22:23] offset:2048 sc1
    global_load_dwordx4 a[44:47], v2, s[22:23] offset:3072 sc1
    s_add_u32 s22, s22, 4096
    s_addc_u32 s23, s23, 0
    global_load_dwordx4 a[48:51], v2, s[22:23] offset:0 sc1
    global_load_dwordx4 a[52:55], v2, s[22:23] offset:1024 sc1
    global_load_dwordx4 a[56:59], v2, s[22:23] offset:2048 sc1
    global_load_dwordx4 a[60:63], v2, s[22:23] offset:3072 sc1
    s_add_u32 s22, s22, 4096
    s_addc_u32 s23, s23, 0
    ds_read_b128 v[96:99], v117 offset:0
    ds_read_b128 v[100:103], v117 offset:32
    v_mov_b32 v80, 0
    v_mov_b32 v81, 0
    v_mov_b32 v82, 0
    v_mov_b32 v83, 0
    v_mov_b32 v84, 0
    v_mov_b32 v85, 0
    v_mov_b32 v86, 0
    v_mov_b32 v87, 0
    v_mov_b32 v88, 0
    v_mov_b32 v89, 0
    v_mov_b32 v90, 0
    v_mov_b32 v91, 0
    v_mov_b32 v92, 0
    v_mov_b32 v93, 0
    v_mov_b32 v94, 0
    v_mov_b32 v95, 0
    v_add_u32 v115, 0x100000, v116
    v_add_u32 v119, 0x100000, v118
    s_waitcnt vmcnt(16)
    s_barrier
    s_cmp_lg_u32 s50, 1
    s_cbranch_scc1 L_f3b_s
    s_add_u32 s80, s10, 0xc000
    v_lshl_add_u32 v73, v1, 10, s80
    v_mov_b32 v74, s81
    s_mov_b64 exec, 1
    global_store_dword v73, v74, s[14:15] sc1
    s_mov_b64 exec, -1
L_f3b_s:
    s_waitcnt vmcnt(15)
    v_mfma_f32_32x32x16_bf16 v[16:31], a[128:131], a[0:3], 0
    global_load_dwordx4 a[64:67], v2, s[22:23] offset:0 sc1
    v_mfma_f32_32x32x16_bf16 v[32:47], a[132:135], a[0:3], 0
    s_waitcnt vmcnt(15)
    v_mfma_f32_32x32x16_bf16 v[16:31], a[136:139], a[4:7], v[16:31]
    global_load_dwordx4 a[68:71], v2, s[22:23] offset:1024 sc1
    v_mfma_f32_32x32x16_bf16 v[32:47], a[140:143], a[4:7], v[32:47]
    s_waitcnt vmcnt(15)
    v_mfma_f32_32x32x16_bf16 v[16:31], a[144:147], a[8:11], v[16:31]
    global_load_dwordx4 a[72:75], v2, s[22:23] offset:2048 sc1
    v_mfma_f32_32x32x16_bf16 v[32:47], a[148:151], a[8:11], v[32:47]
    s_waitcnt vmcnt(15)
    v_mfma_f32_32x32x16_bf16 v[16:31], a[152:155], a[12:15], v[16:31]
    global_load_dwordx4 a[76:79], v2, s[22:23] offset:3072 sc1
    s_add_u32 s22, s22, 4096
    s_addc_u32 s23, s23, 0
    v_mfma_f32_32x32x16_bf16 v[32:47], a[156:159], a[12:15], v[32:47]
    s_waitcnt vmcnt(15)
    v_mfma_f32_32x32x16_bf16 v[16:31], a[160:163], a[16:19], v[16:31]
    global_load_dwordx4 a[80:83], v2, s[22:23] offset:0 sc1
    v_mfma_f32_32x32x16_bf16 v[32:47], a[164:167], a[16:19], v[32:47]
    s_waitcnt vmcnt(15)
    v_mfma_f32_32x32x16_bf16 v[16:31], a[168:171], a[20:23], v[16:31]
    global_load_dwordx4 a[84:87], v2, s[22:23] offset:1024 sc1
    v_mfma_f32_32x32x16_bf16 v[32:47], a[172:175], a[20:23], v[32:47]
    s_waitcnt vmcnt(15)
    v_mfma_f32_32x32x16_bf16 v[16:31], a[176:179], a[24:27], v[16:31]
    global_load_dwordx4 a[88:91], v2, s[22:23] offset:2048 sc1
    v_mfma_f32_32x32x16_bf16 v[32:47], a[180:183], a[24:27], v[32:47]
    s_waitcnt vmcnt(15)
    v_mfma_f32_32x32x16_bf16 v[16:31], a[184:187], a[28:31], v[16:31]
    global_load_dwordx4 a[92:95], v2, s[22:23] offset:3072 sc1
    s_add_u32 s22, s22, 4096
    s_addc_u32 s23, s23, 0
    v_mfma_f32_32x32x16_bf16 v[32:47], a[188:191], a[28:31], v[32:47]
    s_waitcnt vmcnt(15)
    v_mfma_f32_32x32x16_bf16 v[16:31], a[192:195], a[32:35], v[16:31]
    global_load_dwordx4 a[96:99], v2, s[22:23] offset:0 sc1
    v_mfma_f32_32x32x16_bf16 v[32:47], a[196:199], a[32:35], v[32:47]
    s_waitcnt vmcnt(15)
    v_mfma_f32_32x32x16_bf16 v[16:31], a[200:203], a[36:39], v[16:31]
    global_load_dwordx4 a[100:103], v2, s[22:23] offset:1024 sc1
    v_mfma_f32_32x32x16_bf16 v[32:47], a[204:207], a[36:39], v[32:47]
    s_waitcnt vmcnt(15)
    v_mfma_f32_32x32x16_bf16 v[16:31], a[208:211], a[40:43], v[16:31]
    global_load_dwordx4 a[104:107], v2, s[22:23] offset:2048 sc1
    v_mfma_f32_32x32x16_bf16 v[32:47], a[212:215], a[40:43], v[32:47]
    s_nop 0
    s_waitcnt vmcnt(15)
    v_mfma_f32_32x32x16_bf16 v[16:31], a[216:219], a[44:47], v[16:31]
    global_load_dwordx4 a[108:111], v2, s[22:23] offset:3072 sc1
    s_add_u32 s22, s22, 3645440
    s_addc_u32 s23, s23, 0
    v_mfma_f32_32x32x16_bf16 v[32:47], a[220:223], a[44:47], v[32:47]
    s_waitcnt vmcnt(15)
    v_mfma_f32_32x32x16_bf16 v[16:31], a[224:227], a[48:51], v[16:31]
    global_load_short_d16_hi v80, v116, s[20:21] offset:0 sc1
    v_mfma_f32_32x32x16_bf16 v[32:47], a[228:231], a[48:51], v[32:47]
    s_waitcnt vmcnt(15)
    v_mfma_f32_32x32x16_bf16 v[16:31], a[232:235], a[52:55], v[16:31]
    global_load_short_d16_hi v81, v116, s[20:21] offset:64 sc1
    v_mfma_f32_32x32x16_bf16 v[32:47], a[236:239], a[52:55], v[32:47]
    s_waitcnt vmcnt(15)
    v_mfma_f32_32x32x16_bf16 v[16:31], a[240:243], a[56:59], v[16:31]
    global_load_short_d16_hi v82, v116, s[20:21] offset:128 sc1
    v_mfma_f32_32x32x16_bf16 v[32:47], a[244:247], a[56:59], v[32:47]
    s_waitcnt vmcnt(15)
    v_mfma_f32_32x32x16_bf16 v[16:31], a[248:251], a[60:63], v[16:31]
    global_load_short_d16_hi v83, v116, s[20:21] offset:192 sc1
    v_mfma_f32_32x32x16_bf16 v[32:47], a[252:255], a[60:63], v[32:47]
    s_waitcnt vmcnt(15)
    s_cmp_lg_u32 s50, 1
    s_cbranch_scc1 L_f3b_i
    global_load_dword v72, v122, s[14:15] offset:1024 sc1
L_f3b_i:
    v_mfma_f32_32x32x16_bf16 v[16:31], v[160:163], a[64:67], v[16:31]
    global_load_short_d16_hi v84, v116, s[20:21] offset:512 sc1
    v_mfma_f32_32x32x16_bf16 v[32:47], v[164:167], a[64:67], v[32:47]
    s_waitcnt vmcnt(15)
    v_mfma_f32_32x32x16_bf16 v[16:31], v[168:171], a[68:71], v[16:31]
    global_load_short_d16_hi v85, v116, s[20:21] offset:576 sc1
    v_mfma_f32_32x32x16_bf16 v[32:47], v[172:175], a[68:71], v[32:47]
    s_waitcnt vmcnt(15)
    v_mfma_f32_32x32x16_bf16 v[16:31], v[176:179], a[72:75], v[16:31]
    global_load_short_d16_hi v86, v116, s[20:21] offset:640 sc1
    v_mfma_f32_32x32x16_bf16 v[32:47], v[180:183], a[72:75], v[32:47]
    s_waitcnt vmcnt(15)
    v_mfma_f32_32x32x16_bf16 v[16:31], v[184:187], a[76:79], v[16:31]
    global_load_short_d16_hi v87, v116, s[20:21] offset:704 sc1
    v_mfma_f32_32x32x16_bf16 v[32:47], v[188:191], a[76:79], v[32:47]
    s_waitcnt vmcnt(15)
    v_mfma_f32_32x32x16_bf16 v[16:31], v[192:195], a[80:83], v[16:31]
    v_mfma_f32_32x32x16_bf16 v[32:47], v[196:199], a[80:83], v[32:47]
    s_waitcnt vmcnt(14)
    v_mfma_f32_32x32x16_bf16 v[16:31], v[200:203], a[84:87], v[16:31]
    v_mfma_f32_32x32x16_bf16 v[32:47], v[204:207], a[84:87], v[32:47]
    s_waitcnt vmcnt(13)
    v_mfma_f32_32x32x16_bf16 v[16:31], v[208:211], a[88:91], v[16:31]
    v_mfma_f32_32x32x16_bf16 v[32:47], v[212:215], a[88:91], v[32:47]
    s_waitcnt vmcnt(12)
    v_mfma_f32_32x32x16_bf16 v[16:31], v[216:219], a[92:95], v[16:31]
    v_mfma_f32_32x32x16_bf16 v[32:47], v[220:223], a[92:95], v[32:47]
    s_waitcnt vmcnt(11)
    s_cmp_lg_u32 s50, 1
    s_cbranch_scc1 L_f3b_w
    s_mov_b32 s80, 0
    s_waitcnt vmcnt(4)
L_f3b_p:
    v_cmp_ne_u32 vcc, s81, v72
    s_nop 0
    s_cbranch_vccz L_f3b_w
    s_add_u32 s80, s80, 1
    s_cmp_gt_u32 s80, 0x80000
    s_cbranch_scc1 L_f3b_w
    s_sleep 1
    global_load_dword v72, v122, s[14:15] offset:1024 sc1
    s_waitcnt vmcnt(0)
    s_branch L_f3b_p
L_f3b_w:
    s_barrier
    v_mfma_f32_32x32x16_bf16 v[16:31], v[224:227], a[96:99], v[16:31]
    global_load_dwordx4 a[0:3], v2, s[22:23] offset:0 sc1
    v_mfma_f32_32x32x16_bf16 v[32:47], v[228:231], a[96:99], v[32:47]
    global_load_dwordx4 a[4:7], v2, s[22:23] offset:1024 sc1
    s_waitcnt vmcnt(12)
    v_mfma_f32_32x32x16_bf16 v[16:31], v[232:235], a[100:103], v[16:31]
    global_load_dwordx4 a[8:11], v2, s[22:23] offset:2048 sc1
    v_mfma_f32_32x32x16_bf16 v[32:47], v[236:239], a[100:103], v[32:47]
    global_load_dwordx4 a[12:15], v2, s[22:23] offset:3072 sc1
    s_add_u32 s22, s22, 4096
    s_addc_u32 s23, s23, 0
    s_waitcnt vmcnt(13)
    v_mfma_f32_32x32x16_bf16 v[16:31], v[240:243], a[104:107], v[16:31]
    global_load_dwordx4 a[16:19], v2, s[22:23] offset:0 sc1
    v_mfma_f32_32x32x16_bf16 v[32:47], v[244:247], a[104:107], v[32:47]
    global_load_dwordx4 a[20:23], v2, s[22:23] offset:1024 sc1
    s_nop 0
    s_waitcnt vmcnt(14)
    v_mfma_f32_32x32x16_bf16 v[16:31], v[248:251], a[108:111], v[16:31]
    global_load_dwordx4 a[24:27], v2, s[22:23] offset:2048 sc1
    v_mfma_f32_32x32x16_bf16 v[32:47], v[252:255], a[108:111], v[32:47]
    global_load_dwordx4 a[28:31], v2, s[22:23] offset:3072 sc1
    s_add_u32 s22, s22, 4096
    s_addc_u32 s23, s23, 0
    s_nop 6
    ds_write_b128 v120, v[16:19] offset:0
    ds_write_b128 v120, v[20:23] offset:1024
    global_load_dwordx4 a[32:35], v2, s[22:23] offset:0 sc1
    ds_write_b128 v120, v[24:27] offset:2048
    ds_write_b128 v120, v[28:31] offset:3072
    global_load_dwordx4 a[36:39], v2, s[22:23] offset:1024 sc1
    ds_write_b128 v120, v[32:35] offset:4096
    ds_write_b128 v120, v[36:39] offset:5120
    global_load_dwordx4 a[40:43], v2, s[22:23] offset:2048 sc1
    ds_write_b128 v120, v[40:43] offset:6144
    ds_write_b128 v120, v[44:47] offset:7168
    global_load_dwordx4 a[44:47], v2, s[22:23] offset:3072 sc1
    s_add_u32 s22, s22, 4096
    s_addc_u32 s23, s23, 0
    s_waitcnt lgkmcnt(0)
    s_nop 0
    s_barrier
    ds_read_b128 v[48:51], v121 offset:0
    ds_read_b128 v[52:55], v121 offset:1024
    ds_read_b128 v[56:59], v121 offset:8192
    ds_read_b128 v[60:63], v121 offset:9216
    ds_read_b128 v[64:67], v121 offset:16384
    ds_read_b128 v[68:71], v121 offset:17408
    ds_read_b128 v[72:75], v121 offset:24576
    ds_read_b128 v[76:79], v121 offset:25600
    global_load_dwordx4 a[48:51], v2, s[22:23] offset:0 sc1
    global_load_dwordx4 a[52:55], v2, s[22:23] offset:1024 sc1
    global_load_dwordx4 a[56:59], v2, s[22:23] offset:2048 sc1
    global_load_dwordx4 a[60:63], v2, s[22:23] offset:3072 sc1
    s_add_u32 s22, s22, 4096
    s_nop 0
    s_addc_u32 s23, s23, 0
    global_load_dwordx4 a[64:67], v2, s[22:23] offset:0 sc1
    global_load_dwordx4 a[68:71], v2, s[22:23] offset:1024 sc1
    global_load_dwordx4 a[72:75], v2, s[22:23] offset:2048 sc1
    global_load_dwordx4 a[76:79], v2, s[22:23] offset:3072 sc1
    s_add_u32 s22, s22, 4096
    s_addc_u32 s23, s23, 0
    s_waitcnt lgkmcnt(4)
    v_pk_add_f32 v[48:49], v[48:49], v[56:57]
    v_pk_add_f32 v[50:51], v[50:51], v[58:59]
    v_pk_add_f32 v[52:53], v[52:53], v[60:61]
    v_pk_add_f32 v[54:55], v[54:55], v[62:63]
    s_waitcnt lgkmcnt(0)
    v_pk_add_f32 v[64:65], v[64:65], v[72:73]
    v_pk_add_f32 v[66:67], v[66:67], v[74:75]
    v_pk_add_f32 v[68:69], v[68:69], v[76:77]
    v_pk_add_f32 v[70:71], v[70:71], v[78:79]
    s_waitcnt vmcnt(20)
    v_pk_add_f32 v[48:49], v[48:49], v[64:65]
    v_pk_fma_f32 v[48:49], v[48:49], v[96:97], v[80:81]
    v_cvt_pk_bf16_f32 v104, v48, v49
    v_pk_add_f32 v[50:51], v[50:51], v[66:67]
    v_pk_fma_f32 v[50:51], v[50:51], v[98:99], v[82:83]
    v_cvt_pk_bf16_f32 v105, v50, v51
    v_pk_add_f32 v[52:53], v[52:53], v[68:69]
    v_pk_fma_f32 v[52:53], v[52:53], v[100:101], v[84:85]
    v_cvt_pk_bf16_f32 v106, v52, v53
    v_pk_add_f32 v[54:55], v[54:55], v[70:71]
    v_pk_fma_f32 v[54:55], v[54:55], v[102:103], v[86:87]
    v_cvt_pk_bf16_f32 v107, v54, v55
    v_permlane32_swap_b32 v104, v106
    s_nop 0
    v_permlane32_swap_b32 v105, v107
    global_store_dwordx4 v118, v[104:107], s[24:25]
    s_waitcnt vmcnt(20)
    v_mfma_f32_32x32x16_bf16 v[16:31], a[128:131], a[0:3], 0
    global_load_dwordx4 a[80:83], v2, s[22:23] offset:0 sc1
    v_mfma_f32_32x32x16_bf16 v[32:47], a[132:135], a[0:3], 0
    s_waitcnt vmcnt(20)
    v_mfma_f32_32x32x16_bf16 v[16:31], a[136:139], a[4:7], v[16:31]
    global_load_dwordx4 a[84:87], v2, s[22:23] offset:1024 sc1
    v_mfma_f32_32x32x16_bf16 v[32:47], a[140:143], a[4:7], v[32:47]
    s_waitcnt vmcnt(20)
    v_mfma_f32_32x32x16_bf16 v[16:31], a[144:147], a[8:11], v[16:31]
    global_load_dwordx4 a[88:91], v2, s[22:23] offset:2048 sc1
    v_mfma_f32_32x32x16_bf16 v[32:47], a[148:151], a[8:11], v[32:47]
    s_nop 0
    s_waitcnt vmcnt(20)
    v_mfma_f32_32x32x16_bf16 v[16:31], a[152:155], a[12:15], v[16:31]
    global_load_dwordx4 a[92:95], v2, s[22:23] offset:3072 sc1
    s_add_u32 s22, s22, 4096
    s_addc_u32 s23, s23, 0
    v_mfma_f32_32x32x16_bf16 v[32:47], a[156:159], a[12:15], v[32:47]
    s_waitcnt vmcnt(20)
    v_mfma_f32_32x32x16_bf16 v[16:31], a[160:163], a[16:19], v[16:31]
    global_load_dwordx4 a[96:99], v2, s[22:23] offset:0 sc1
    v_mfma_f32_32x32x16_bf16 v[32:47], a[164:167], a[16:19], v[32:47]
    s_waitcnt vmcnt(20)
    v_mfma_f32_32x32x16_bf16 v[16:31], a[168:171], a[20:23], v[16:31]
    global_load_dwordx4 a[100:103], v2, s[22:23] offset:1024 sc1
    v_mfma_f32_32x32x16_bf16 v[32:47], a[172:175], a[20:23], v[32:47]
    s_waitcnt vmcnt(20)
    v_mfma_f32_32x32x16_bf16 v[16:31], a[176:179], a[24:27], v[16:31]
    global_load_dwordx4 a[104:107], v2, s[22:23] offset:2048 sc1
    v_mfma_f32_32x32x16_bf16 v[32:47], a[180:183], a[24:27], v[32:47]
    s_waitcnt vmcnt(20)
    v_mfma_f32_32x32x16_bf16 v[16:31], a[184:187], a[28:31], v[16:31]
    global_load_dwordx4 a[108:111], v2, s[22:23] offset:3072 sc1
    v_mfma_f32_32x32x16_bf16 v[32:47], a[188:191], a[28:31], v[32:47]
    s_waitcnt vmcnt(20)
    v_mfma_f32_32x32x16_bf16 v[16:31], a[192:195], a[32:35], v[16:31]
    v_mfma_f32_32x32x16_bf16 v[32:47], a[196:199], a[32:35], v[32:47]
    s_waitcnt vmcnt(19)
    v_mfma_f32_32x32x16_bf16 v[16:31], a[200:203], a[36:39], v[16:31]
    v_mfma_f32_32x32x16_bf16 v[32:47], a[204:207], a[36:39], v[32:47]
    s_waitcnt vmcnt(18)
    v_mfma_f32_32x32x16_bf16 v[16:31], a[208:211], a[40:43], v[16:31]
    global_load_short_d16_hi v88, v115, s[20:21] offset:0 sc1
    v_mfma_f32_32x32x16_bf16 v[32:47], a[212:215], a[40:43], v[32:47]
    s_waitcnt vmcnt(18)
    v_mfma_f32_32x32x16_bf16 v[16:31], a[216:219], a[44:47], v[16:31]
    global_load_short_d16_hi v89, v115, s[20:21] offset:64 sc1
    v_mfma_f32_32x32x16_bf16 v[32:47], a[220:223], a[44:47], v[32:47]
    s_waitcnt vmcnt(18)
    v_mfma_f32_32x32x16_bf16 v[16:31], a[224:227], a[48:51], v[16:31]
    global_load_short_d16_hi v90, v115, s[20:21] offset:128 sc1
    v_mfma_f32_32x32x16_bf16 v[32:47], a[228:231], a[48:51], v[32:47]
    s_waitcnt vmcnt(18)
    v_mfma_f32_32x32x16_bf16 v[16:31], a[232:235], a[52:55], v[16:31]
    global_load_short_d16_hi v91, v115, s[20:21] offset:192 sc1
    v_mfma_f32_32x32x16_bf16 v[32:47], a[236:239], a[52:55], v[32:47]
    s_waitcnt vmcnt(18)
    v_mfma_f32_32x32x16_bf16 v[16:31], a[240:243], a[56:59], v[16:31]
    global_load_short_d16_hi v92, v115, s[20:21] offset:512 sc1
    v_mfma_f32_32x32x16_bf16 v[32:47], a[244:247], a[56:59], v[32:47]
    s_waitcnt vmcnt(18)
    v_mfma_f32_32x32x16_bf16 v[16:31], a[248:251], a[60:63], v[16:31]
    global_load_short_d16_hi v93, v115, s[20:21] offset:576 sc1
    v_mfma_f32_32x32x16_bf16 v[32:47], a[252:255], a[60:63], v[32:47]
    s_waitcnt vmcnt(18)
    v_mfma_f32_32x32x16_bf16 v[16:31], v[160:163], a[64:67], v[16:31]
    global_load_short_d16_hi v94, v115, s[20:21] offset:640 sc1
    v_mfma_f32_32x32x16_bf16 v[32:47], v[164:167], a[64:67], v[32:47]
    s_waitcnt vmcnt(18)
    v_mfma_f32_32x32x16_bf16 v[16:31], v[168:171], a[68:71], v[16:31]
    global_load_short_d16_hi v95, v115, s[20:21] offset:704 sc1
    v_mfma_f32_32x32x16_bf16 v[32:47], v[172:175], a[68:71], v[32:47]
    s_waitcnt vmcnt(18)
    v_mfma_f32_32x32x16_bf16 v[16:31], v[176:179], a[72:75], v[16:31]
    v_mfma_f32_32x32x16_bf16 v[32:47], v[180:183], a[72:75], v[32:47]
    s_waitcnt vmcnt(17)
    v_mfma_f32_32x32x16_bf16 v[16:31], v[184:187], a[76:79], v[16:31]
    v_mfma_f32_32x32x16_bf16 v[32:47], v[188:191], a[76:79], v[32:47]
    s_waitcnt vmcnt(15)
    v_mfma_f32_32x32x16_bf16 v[16:31], v[192:195], a[80:83], v[16:31]
    v_mfma_f32_32x32x16_bf16 v[32:47], v[196:199], a[80:83], v[32:47]
    s_waitcnt vmcnt(14)
    v_mfma_f32_32x32x16_bf16 v[16:31], v[200:203], a[84:87], v[16:31]
    v_mfma_f32_32x32x16_bf16 v[32:47], v[204:207], a[84:87], v[32:47]
    s_waitcnt vmcnt(13)
    v_mfma_f32_32x32x16_bf16 v[16:31], v[208:211], a[88:91], v[16:31]
    v_mfma_f32_32x32x16_bf16 v[32:47], v[212:215], a[88:91], v[32:47]
    s_waitcnt vmcnt(12)
    v_mfma_f32_32x32x16_bf16 v[16:31], v[216:219], a[92:95], v[16:31]
    v_mfma_f32_32x32x16_bf16 v[32:47], v[220:223], a[92:95], v[32:47]
    s_waitcnt vmcnt(11)
    v_mfma_f32_32x32x16_bf16 v[16:31], v[224:227], a[96:99], v[16:31]
    v_mfma_f32_32x32x16_bf16 v[32:47], v[228:231], a[96:99], v[32:47]
    s_waitcnt vmcnt(10)
    v_mfma_f32_32x32x16_bf16 v[16:31], v[232:235], a[100:103], v[16:31]
    v_mfma_f32_32x32x16_bf16 v[32:47], v[236:239], a[100:103], v[32:47]
    s_waitcnt vmcnt(9)
    v_mfma_f32_32x32x16_bf16 v[16:31], v[240:243], a[104:107], v[16:31]
    v_mfma_f32_32x32x16_bf16 v[32:47], v[244:247], a[104:107], v[32:47]
    s_waitcnt vmcnt(8)
    v_mfma_f32_32x32x16_bf16 v[16:31], v[248:251], a[108:111], v[16:31]
    v_mfma_f32_32x32x16_bf16 v[32:47], v[252:255], a[108:111], v[32:47]
    s_nop 10
    ds_write_b128 v120, v[16:19] offset:32768
    ds_write_b128 v120, v[20:23] offset:33792
    ds_write_b128 v120, v[24:27] offset:34816
    ds_write_b128 v120, v[28:31] offset:35840
    ds_write_b128 v120, v[32:35] offset:36864
    ds_write_b128 v120, v[36:39] offset:37888
    ds_write_b128 v120, v[40:43] offset:38912
    ds_write_b128 v120, v[44:47] offset:39936
    s_waitcnt lgkmcnt(0)
    s_barrier
    ds_read_b128 v[48:51], v121 offset:32768
    ds_read_b128 v[52:55], v121 offset:33792
    ds_read_b128 v[56:59], v121 offset:40960
    ds_read_b128 v[60:63], v121 offset:41984
    ds_read_b128 v[64:67], v121 offset:49152
    ds_read_b128 v[68:71], v121 offset:50176
    ds_read_b128 v[72:75], v121 offset:57344
    ds_read_b128 v[76:79], v121 offset:58368
    s_waitcnt lgkmcnt(4)
    v_pk_add_f32 v[48:49], v[48:49], v[56:57]
    v_pk_add_f32 v[50:51], v[50:51], v[58:59]
    v_pk_add_f32 v[52:53], v[52:53], v[60:61]
    v_pk_add_f32 v[54:55], v[54:55], v[62:63]
    s_waitcnt lgkmcnt(0)
    v_pk_add_f32 v[64:65], v[64:65], v[72:73]
    v_pk_add_f32 v[66:67], v[66:67], v[74:75]
    v_pk_add_f32 v[68:69], v[68:69], v[76:77]
    v_pk_add_f32 v[70:71], v[70:71], v[78:79]
    s_nop 0
    s_waitcnt vmcnt(0)
    v_pk_add_f32 v[48:49], v[48:49], v[64:65]
    v_pk_fma_f32 v[48:49], v[48:49], v[96:97], v[88:89]
    v_cvt_pk_bf16_f32 v108, v48, v49
    v_pk_add_f32 v[50:51], v[50:51], v[66:67]
    v_pk_fma_f32 v[50:51], v[50:51], v[98:99], v[90:91]
    v_cvt_pk_bf16_f32 v109, v50, v51
    v_pk_add_f32 v[52:53], v[52:53], v[68:69]
    v_pk_fma_f32 v[52:53], v[52:53], v[100:101], v[92:93]
    v_cvt_pk_bf16_f32 v110, v52, v53
    v_pk_add_f32 v[54:55], v[54:55], v[70:71]
    v_pk_fma_f32 v[54:55], v[54:55], v[102:103], v[94:95]
    v_cvt_pk_bf16_f32 v111, v54, v55
    v_permlane32_swap_b32 v108, v110
    s_nop 0
    v_permlane32_swap_b32 v109, v111
    global_store_dwordx4 v119, v[108:111], s[24:25]
    s_endpgm
L_end:
    s_endpgm
.section .rodata,"a"
.p2align 6
.amdhsa_kernel adaLN_cond__ssm_conv_s4__dense_activation_silu__prompt_kernel
  .amdhsa_next_free_vgpr 512
  .amdhsa_next_free_sgpr 84
  .amdhsa_accum_offset 256
  .amdhsa_group_segment_fixed_size 0
  .amdhsa_kernarg_size 136
  .amdhsa_user_sgpr_count 2
  .amdhsa_user_sgpr_kernarg_segment_ptr 1
  .amdhsa_system_sgpr_workgroup_id_x 1
.end_amdhsa_kernel
.text
L_text_end:
    s_endpgm
```
